```python
import torch

def _softmax(x, axis=-1):
    return torch.softmax(x, dim=axis)
def _gelu(x):
    return torch.nn.functional.gelu(x, approximate="tanh")
def _silu(x):
    return torch.nn.functional.silu(x)
def _sigmoid(x):
    return torch.sigmoid(x)
def _layernorm(x, axis=-1, eps=1e-5):
    m = x.mean(dim=axis, keepdim=True)
    v = x.var(dim=axis, keepdim=True, unbiased=False)
    return (x - m) / torch.sqrt(v + eps)
def _scatter_add(tgt, idx, src, axis=0):
    return tgt.clone().index_add_(axis, idx, src)
def _segment_sum(src, seg, n):
    out = torch.zeros((n,) + src.shape[1:], dtype=src.dtype)
    return out.index_add_(0, seg, src)
def _pad(x, pw):
    flat = tuple(v for pair in reversed(pw) for v in pair)
    return torch.nn.functional.pad(x, flat)

kernel_name = 'concat_heads__grouped_kv_mqa__linear_kernel_hedgehog__prompt'

def setup_inputs():

    _w = (lambda a: (lambda t: t.to(torch.bfloat16) if t.is_floating_point() else t)(torch.as_tensor(a)))
    def _A_setup():
        B, S, D, H = 1, 2048, 640, 32
        Dh = D // H
        return {
            "x": _w((lambda *s: torch.randn(*s, dtype=torch.bfloat16) * 0.05)(B, S, D)),
            "wq": _w((lambda *s: torch.randn(*s, dtype=torch.bfloat16) * 1.6)(D, H * Dh)),
            "wk": _w((lambda *s: torch.randn(*s, dtype=torch.bfloat16) * 1.6)(D, Dh)),
            "wv": _w((lambda *s: torch.randn(*s, dtype=torch.bfloat16) * 0.1)(D, Dh)),
            "wo": _w((lambda *s: torch.randn(*s, dtype=torch.bfloat16) * 0.1)(H * Dh, D)),
        }
    _A_in = _A_setup()

    def _B_setup():
        B, S, D, H = 1, 2048, 640, 32
        Dh = D // H
        return {
            "x": _w((lambda *s: torch.randn(*s, dtype=torch.bfloat16) * 0.4)(B, S, D)),
            "wqkv": _w((lambda *s: torch.randn(*s, dtype=torch.bfloat16) * 0.4)(D, 3 * D)),
            "w_phi": _w((lambda *s: torch.randn(*s, dtype=torch.bfloat16) * 0.4)(H, Dh, Dh) * (Dh ** -0.5)),
            "wo": _w((lambda *s: torch.randn(*s, dtype=torch.bfloat16) * 0.05)(D, D)),
        }
    _B_in = _B_setup()

    return {
        "A_x": _A_in["x"],
        "A_wq": _A_in["wq"],
        "A_wk": _A_in["wk"],
        "A_wv": _A_in["wv"],
        "A_wo": _A_in["wo"],
        "B_x": _B_in["x"],
        "B_wqkv": _B_in["wqkv"],
        "B_w_phi": _B_in["w_phi"],
        "B_wo": _B_in["wo"],
    }

def reference(A_x, A_wq, A_wk, A_wv, A_wo, B_x, B_wqkv, B_w_phi, B_wo):
    def _A_ref(x, wq, wk, wv, wo):
        B, S, D = x.shape
        H = 32
        Dh = D // H
        q = (lambda x, *d: x.permute(*d))((x @ wq).reshape(B, S, H, Dh), 0, 2, 1, 3)
        k = x @ wk
        v = x @ wv
        scores = torch.einsum("bhqd,bkd->bhqk", q, k) * (Dh ** -0.5)
        p = _softmax(scores, axis=-1)
        o = torch.einsum("bhqk,bkd->bhqd", p, v)
        return (lambda x, *d: x.permute(*d))(o, 0, 2, 1, 3).reshape(B, S, H * Dh) @ wo

    def _B_ref(x, wqkv, w_phi, wo):
        B, S, D = x.shape
        H = 32; Dh = D // H
        qkv = (lambda x, *d: x.permute(*d))((x @ wqkv).reshape(B, S, 3, H, Dh), 2, 0, 3, 1, 4)
        q, k, v = qkv[0], qkv[1], qkv[2]
        pq = torch.einsum("bhsd,hdf->bhsf", q, w_phi)
        pk = torch.einsum("bhsd,hdf->bhsf", k, w_phi)
        phi_q = torch.concatenate([_softmax(pq, axis=-1), _softmax(-pq, axis=-1)], axis=-1)
        phi_k = torch.concatenate([_softmax(pk, axis=-1), _softmax(-pk, axis=-1)], axis=-1)
        kv = torch.einsum("bhsf,bhsd->bhfd", phi_k, v)
        z  = torch.einsum("bhsf->bhf", phi_k)
        num = torch.einsum("bhqf,bhfd->bhqd", phi_q, kv)
        den = torch.einsum("bhqf,bhf->bhq", phi_q, z)[..., None] + 1e-6
        o = num / den
        return (lambda x, *d: x.permute(*d))(o, 0, 2, 1, 3).reshape(B, S, D) @ wo

    a = _A_ref(A_x, A_wq, A_wk, A_wv, A_wo)
    b = _B_ref(B_x, B_wqkv, B_w_phi, B_wo)
    return torch.concatenate([a, b], axis=-1)
```

```asm
; @launch kernel=fused_kernel grid=(256,1,1) block=(512,1,1) lds=157696
.amdgcn_target "amdgcn-amd-amdhsa--gfx950"
.text
.p2align 8
.globl fused_kernel
.type fused_kernel,@function
fused_kernel:
    s_cmp_ge_u32 s2, 256
    s_cbranch_scc1 fused_kernel_end
    s_and_b32 s6, s2, 7
    s_lshl_b32 s6, s6, 5
    s_lshr_b32 s2, s2, 3
    s_or_b32 s2, s2, s6
    s_load_dwordx2 s[4:5], s[0:1], 88
    s_load_dwordx2 s[98:99], s[0:1], 80
    v_lshrrev_b32 v1, 6, v0
    v_and_b32 v228, 63, v0
    v_readfirstlane_b32 s96, v1
    v_lshlrev_b32 v229, 4, v228
    v_mov_b32 v232, 0
    v_mov_b32 v233, 157184
    ds_write_b32 v233, v232
    s_waitcnt lgkmcnt(0)
    s_cmp_eq_u32 s2, 0
    s_cbranch_scc0 G_noinit1
    v_mov_b32 v4, 0
    v_mov_b32 v5, 0
    v_mov_b32 v6, 0
    v_mov_b32 v7, 0
    s_mul_i32 s60, s96, 9216
    s_add_u32 s60, s60, 22020096
    v_add_u32 v8, s60, v229
    global_store_dwordx4 v8, v[4:7], s[4:5] offset:0 sc1
    global_store_dwordx4 v8, v[4:7], s[4:5] offset:1024 sc1
    global_store_dwordx4 v8, v[4:7], s[4:5] offset:2048 sc1
    global_store_dwordx4 v8, v[4:7], s[4:5] offset:3072 sc1
    s_nop 1
    v_add_u32 v8, 4096, v8
    global_store_dwordx4 v8, v[4:7], s[4:5] offset:0 sc1
    global_store_dwordx4 v8, v[4:7], s[4:5] offset:1024 sc1
    global_store_dwordx4 v8, v[4:7], s[4:5] offset:2048 sc1
    global_store_dwordx4 v8, v[4:7], s[4:5] offset:3072 sc1
    s_nop 1
    v_add_u32 v8, 4096, v8
    global_store_dwordx4 v8, v[4:7], s[4:5] sc1
    s_waitcnt vmcnt(0)
    s_barrier
    s_cmp_eq_u32 s96, 0
    s_cbranch_scc0 G_noinit1
    v_mov_b32 v8, 1
    s_mov_b64 exec, 1
    global_store_dword v4, v8, s[98:99] sc1
    s_mov_b64 exec, -1
G_noinit1:
    s_load_dwordx4 s[44:47], s[0:1], 0
    s_load_dwordx4 s[48:51], s[0:1], 16
    s_load_dwordx4 s[52:55], s[0:1], 40
    s_load_dwordx2 s[56:57], s[0:1], 56
    v_mov_b32 v200, v228
    v_mov_b32 v201, v229
    s_mov_b32 s10, s96
    s_and_b32 s14, s2, 7
    s_lshr_b32 s15, s2, 3
    s_lshr_b32 s12, s15, 2
    s_and_b32 s13, s15, 3
    s_mul_i32 s42, s13, 3
    s_add_u32 s42, s42, s12
    s_cmp_ge_u32 s42, 10
    s_cselect_b32 s15, 10, 0
    s_sub_u32 s42, s42, s15
    s_cmp_ge_u32 s14, 2
    s_cbranch_scc1 P1_idsB
    s_lshl_b32 s14, s14, 3
    s_add_u32 s12, s12, s14
    s_add_u32 s11, s13, 1
    s_cmp_ge_u32 s13, 2
    s_cselect_b32 s11, 0, s11
    s_branch P1_idsE
P1_idsB:
    s_sub_u32 s14, s14, 2
    s_and_b32 s15, s14, 1
    s_lshl_b32 s15, s15, 3
    s_add_u32 s12, s12, s15
    s_lshr_b32 s14, s14, 1
    s_cmp_eq_u32 s14, 0
    s_cselect_b32 s11, 3, 4
    s_cbranch_scc1 P1_idsE
    s_sub_u32 s14, s14, 1
    s_lshl_b32 s14, s14, 2
    s_add_u32 s13, s13, s14
P1_idsE:
    s_mov_b32 s30, -1
    s_mov_b32 s31, 0
    s_mov_b32 s32, 0
    s_mov_b32 s33, -1
    s_cmp_ge_u32 s10, 4
    s_cbranch_scc1 P1_loader
    v_and_b32 v202, 31, v200
    v_bfe_u32 v203, v200, 1, 3
    v_lshrrev_b32 v204, 5, v200
    v_lshlrev_b32 v202, 7, v202
    s_lshl_b32 s14, s10, 12
    v_add_u32 v202, s14, v202
    v_add_u32 v205, 0, v204
    v_xor_b32 v205, v205, v203
    v_lshl_add_u32 v158, v205, 4, v202
    v_add_u32 v205, 2, v204
    v_xor_b32 v205, v205, v203
    v_lshl_add_u32 v159, v205, 4, v202
    v_add_u32 v205, 4, v204
    v_xor_b32 v205, v205, v203
    v_lshl_add_u32 v160, v205, 4, v202
    v_add_u32 v205, 6, v204
    v_xor_b32 v205, v205, v203
    v_lshl_add_u32 v161, v205, 4, v202
    v_lshrrev_b32 v202, 5, v200
    v_lshlrev_b32 v202, 3, v202
    v_bfe_u32 v203, v200, 2, 2
    v_add_u32 v202, v202, v203
    v_mul_u32_u24 v162, 320, v202
    v_add_u32 v162, 16384, v162
    v_mul_u32_u24 v163, 40, v202
    v_add_u32 v163, 147456, v163
    v_bfe_u32 v203, v200, 4, 1
    v_lshlrev_b32 v203, 1, v203
    v_bfe_u32 v204, v200, 1, 1
    v_add_u32 v203, v203, v204
    v_and_b32 v204, 1, v200
    v_lshl_add_u32 v205, v203, 1, v204
    v_min_u32 v205, 4, v205
    v_lshl_add_u32 v157, v205, 3, v163
    v_add_u32 v164, 0, v203
    v_mul_u32_u24 v165, 13, v164
    v_lshrrev_b32 v165, 6, v165
    v_mul_u32_u24 v166, 5, v165
    v_sub_u32 v166, v164, v166
    v_lshl_add_u32 v167, v166, 1, v204
    v_cmp_lt_u32 vcc, 2, v166
    v_lshlrev_b32 v168, 2, v204
    v_subrev_u32 v164, 1, v167
    v_cndmask_b32 v167, v167, v164, vcc
    v_cmp_eq_u32 vcc, 2, v166
    v_add_u32 v168, v168, v167
    v_mul_u32_u24 v165, 10, v165
    v_cndmask_b32 v167, v167, v168, vcc
    v_add_u32 v167, v167, v165
    v_lshl_add_u32 v152, v167, 3, v162
    v_add_u32 v164, 4, v203
    v_mul_u32_u24 v165, 13, v164
    v_lshrrev_b32 v165, 6, v165
    v_mul_u32_u24 v166, 5, v165
    v_sub_u32 v166, v164, v166
    v_lshl_add_u32 v167, v166, 1, v204
    v_cmp_lt_u32 vcc, 2, v166
    v_lshlrev_b32 v168, 2, v204
    v_subrev_u32 v164, 1, v167
    v_cndmask_b32 v167, v167, v164, vcc
    v_cmp_eq_u32 vcc, 2, v166
    v_add_u32 v168, v168, v167
    v_mul_u32_u24 v165, 10, v165
    v_cndmask_b32 v167, v167, v168, vcc
    v_add_u32 v167, v167, v165
    v_lshl_add_u32 v153, v167, 3, v162
    v_add_u32 v164, 8, v203
    v_mul_u32_u24 v165, 13, v164
    v_lshrrev_b32 v165, 6, v165
    v_mul_u32_u24 v166, 5, v165
    v_sub_u32 v166, v164, v166
    v_lshl_add_u32 v167, v166, 1, v204
    v_cmp_lt_u32 vcc, 2, v166
    v_lshlrev_b32 v168, 2, v204
    v_subrev_u32 v164, 1, v167
    v_cndmask_b32 v167, v167, v164, vcc
    v_cmp_eq_u32 vcc, 2, v166
    v_add_u32 v168, v168, v167
    v_mul_u32_u24 v165, 10, v165
    v_cndmask_b32 v167, v167, v168, vcc
    v_add_u32 v167, v167, v165
    v_lshl_add_u32 v154, v167, 3, v162
    v_add_u32 v164, 12, v203
    v_mul_u32_u24 v165, 13, v164
    v_lshrrev_b32 v165, 6, v165
    v_mul_u32_u24 v166, 5, v165
    v_sub_u32 v166, v164, v166
    v_lshl_add_u32 v167, v166, 1, v204
    v_cmp_lt_u32 vcc, 2, v166
    v_lshlrev_b32 v168, 2, v204
    v_subrev_u32 v164, 1, v167
    v_cndmask_b32 v167, v167, v164, vcc
    v_cmp_eq_u32 vcc, 2, v166
    v_add_u32 v168, v168, v167
    v_mul_u32_u24 v165, 10, v165
    v_cndmask_b32 v167, v167, v168, vcc
    v_add_u32 v167, v167, v165
    v_lshl_add_u32 v155, v167, 3, v162
    v_add_u32 v164, 16, v203
    v_mul_u32_u24 v165, 13, v164
    v_lshrrev_b32 v165, 6, v165
    v_mul_u32_u24 v166, 5, v165
    v_sub_u32 v166, v164, v166
    v_lshl_add_u32 v167, v166, 1, v204
    v_cmp_lt_u32 vcc, 2, v166
    v_lshlrev_b32 v168, 2, v204
    v_subrev_u32 v164, 1, v167
    v_cndmask_b32 v167, v167, v164, vcc
    v_cmp_eq_u32 vcc, 2, v166
    v_add_u32 v168, v168, v167
    v_mul_u32_u24 v165, 10, v165
    v_cndmask_b32 v167, v167, v168, vcc
    v_add_u32 v167, v167, v165
    v_lshl_add_u32 v156, v167, 3, v162
    v_mov_b32 v144, 0
    v_mov_b32 v145, 0
    v_mov_b32 v146, 0
    v_mov_b32 v147, 0
    s_nop 1
    v_mfma_f32_32x32x16_bf16 v[0:15], v[144:147], v[144:147], 0
    v_mfma_f32_32x32x16_bf16 v[16:31], v[144:147], v[144:147], 0
    v_mfma_f32_32x32x16_bf16 v[32:47], v[144:147], v[144:147], 0
    v_mfma_f32_32x32x16_bf16 v[48:63], v[144:147], v[144:147], 0
    v_mfma_f32_32x32x16_bf16 v[64:79], v[144:147], v[144:147], 0
    v_mfma_f32_32x32x16_bf16 v[80:95], v[144:147], v[144:147], 0
    s_waitcnt lgkmcnt(0)
    s_cmp_eq_u32 s96, 0
    s_cbranch_scc0 G_nochk2
    v_mov_b32 v202, 0
    s_mov_b32 s60, 2000000
G_chk2:
    global_load_dword v203, v202, s[98:99] sc1
    s_waitcnt vmcnt(0)
    v_readfirstlane_b32 s61, v203
    s_sub_u32 s60, s60, 1
    s_cmp_eq_u32 s60, 0
    s_cbranch_scc1 G_nochk2
    s_cmp_eq_u32 s61, 0
    s_cbranch_scc1 G_chk2
G_nochk2:
    s_cmp_eq_u32 s11, 1
    s_cbranch_scc1 P1_mainK
    s_cmp_eq_u32 s11, 2
    s_cbranch_scc1 P1_mainV
    s_barrier
    ds_read_b128 v[144:147], v158
    ds_read_b64_tr_b16 v[96:97], v152
    ds_read_b64_tr_b16 v[98:99], v152 offset:1280
    ds_read_b64_tr_b16 v[100:101], v153
    ds_read_b64_tr_b16 v[102:103], v153 offset:1280
    ds_read_b64_tr_b16 v[104:105], v154
    ds_read_b64_tr_b16 v[106:107], v154 offset:1280
    ds_read_b64_tr_b16 v[108:109], v155
    ds_read_b64_tr_b16 v[110:111], v155 offset:1280
    ds_read_b64_tr_b16 v[112:113], v156
    ds_read_b64_tr_b16 v[114:115], v156 offset:1280
    s_mov_b32 s22, 10
    s_mov_b32 s27, 0
    s_mov_b32 s40, 36864
    s_mov_b32 s41, 2560
    s_waitcnt lgkmcnt(8)
.p2align 6
P1_loop_P:
    s_cmp_eq_u32 s27, 3
    s_cselect_b32 s26, 4294856704, s40
    s_cselect_b32 s29, 4294959616, s41
    s_add_u32 s27, s27, 1
    s_and_b32 s27, s27, 3
    v_mfma_f32_32x32x16_bf16 v[0:15], v[96:99], v[144:147], v[0:15]
    s_waitcnt lgkmcnt(6)
    ds_read_b128 v[148:151], v159
    ds_read_b64_tr_b16 v[120:121], v152 offset:5120
    ds_read_b64_tr_b16 v[122:123], v152 offset:6400
    v_mfma_f32_32x32x16_bf16 v[16:31], v[100:103], v[144:147], v[16:31]
    s_waitcnt lgkmcnt(7)
    ds_read_b64_tr_b16 v[124:125], v153 offset:5120
    ds_read_b64_tr_b16 v[126:127], v153 offset:6400
    v_mfma_f32_32x32x16_bf16 v[32:47], v[104:107], v[144:147], v[32:47]
    s_waitcnt lgkmcnt(7)
    ds_read_b64_tr_b16 v[128:129], v154 offset:5120
    ds_read_b64_tr_b16 v[130:131], v154 offset:6400
    v_mfma_f32_32x32x16_bf16 v[48:63], v[108:111], v[144:147], v[48:63]
    s_waitcnt lgkmcnt(7)
    ds_read_b64_tr_b16 v[132:133], v155 offset:5120
    ds_read_b64_tr_b16 v[134:135], v155 offset:6400
    v_mfma_f32_32x32x16_bf16 v[64:79], v[112:115], v[144:147], v[64:79]
    s_waitcnt lgkmcnt(6)
    ds_read_b64_tr_b16 v[136:137], v156 offset:5120
    ds_read_b64_tr_b16 v[138:139], v156 offset:6400
    v_mfma_f32_32x32x16_bf16 v[0:15], v[120:123], v[148:151], v[0:15]
    s_waitcnt lgkmcnt(6)
    ds_read_b128 v[144:147], v160
    ds_read_b64_tr_b16 v[96:97], v152 offset:10240
    ds_read_b64_tr_b16 v[98:99], v152 offset:11520
    v_mfma_f32_32x32x16_bf16 v[16:31], v[124:127], v[148:151], v[16:31]
    s_waitcnt lgkmcnt(7)
    ds_read_b64_tr_b16 v[100:101], v153 offset:10240
    ds_read_b64_tr_b16 v[102:103], v153 offset:11520
    v_mfma_f32_32x32x16_bf16 v[32:47], v[128:131], v[148:151], v[32:47]
    s_waitcnt lgkmcnt(7)
    ds_read_b64_tr_b16 v[104:105], v154 offset:10240
    ds_read_b64_tr_b16 v[106:107], v154 offset:11520
    v_mfma_f32_32x32x16_bf16 v[48:63], v[132:135], v[148:151], v[48:63]
    s_waitcnt lgkmcnt(7)
    ds_read_b64_tr_b16 v[108:109], v155 offset:10240
    ds_read_b64_tr_b16 v[110:111], v155 offset:11520
    v_mfma_f32_32x32x16_bf16 v[64:79], v[136:139], v[148:151], v[64:79]
    s_waitcnt lgkmcnt(6)
    ds_read_b64_tr_b16 v[112:113], v156 offset:10240
    ds_read_b64_tr_b16 v[114:115], v156 offset:11520
    v_mfma_f32_32x32x16_bf16 v[0:15], v[96:99], v[144:147], v[0:15]
    s_waitcnt lgkmcnt(6)
    ds_read_b128 v[148:151], v161
    ds_read_b64_tr_b16 v[120:121], v152 offset:15360
    ds_read_b64_tr_b16 v[122:123], v152 offset:16640
    v_mfma_f32_32x32x16_bf16 v[16:31], v[100:103], v[144:147], v[16:31]
    s_waitcnt lgkmcnt(7)
    ds_read_b64_tr_b16 v[124:125], v153 offset:15360
    ds_read_b64_tr_b16 v[126:127], v153 offset:16640
    v_mfma_f32_32x32x16_bf16 v[32:47], v[104:107], v[144:147], v[32:47]
    s_waitcnt lgkmcnt(7)
    ds_read_b64_tr_b16 v[128:129], v154 offset:15360
    ds_read_b64_tr_b16 v[130:131], v154 offset:16640
    v_mfma_f32_32x32x16_bf16 v[48:63], v[108:111], v[144:147], v[48:63]
    s_waitcnt lgkmcnt(7)
    ds_read_b64_tr_b16 v[132:133], v155 offset:15360
    ds_read_b64_tr_b16 v[134:135], v155 offset:16640
    v_mfma_f32_32x32x16_bf16 v[64:79], v[112:115], v[144:147], v[64:79]
    s_waitcnt lgkmcnt(6)
    ds_read_b64_tr_b16 v[136:137], v156 offset:15360
    ds_read_b64_tr_b16 v[138:139], v156 offset:16640
    v_mfma_f32_32x32x16_bf16 v[0:15], v[120:123], v[148:151], v[0:15]
    s_waitcnt lgkmcnt(6)
    s_barrier
    v_add_u32 v158, s26, v158
    v_add_u32 v159, s26, v159
    v_add_u32 v160, s26, v160
    v_add_u32 v161, s26, v161
    v_add_u32 v152, s26, v152
    v_add_u32 v153, s26, v153
    v_add_u32 v154, s26, v154
    v_add_u32 v155, s26, v155
    v_add_u32 v156, s26, v156
    ds_read_b128 v[144:147], v158
    ds_read_b64_tr_b16 v[96:97], v152 offset:0
    ds_read_b64_tr_b16 v[98:99], v152 offset:1280
    v_mfma_f32_32x32x16_bf16 v[16:31], v[124:127], v[148:151], v[16:31]
    s_waitcnt lgkmcnt(7)
    ds_read_b64_tr_b16 v[100:101], v153 offset:0
    ds_read_b64_tr_b16 v[102:103], v153 offset:1280
    v_mfma_f32_32x32x16_bf16 v[32:47], v[128:131], v[148:151], v[32:47]
    s_waitcnt lgkmcnt(7)
    ds_read_b64_tr_b16 v[104:105], v154 offset:0
    ds_read_b64_tr_b16 v[106:107], v154 offset:1280
    v_mfma_f32_32x32x16_bf16 v[48:63], v[132:135], v[148:151], v[48:63]
    s_waitcnt lgkmcnt(7)
    ds_read_b64_tr_b16 v[108:109], v155 offset:0
    ds_read_b64_tr_b16 v[110:111], v155 offset:1280
    v_mfma_f32_32x32x16_bf16 v[64:79], v[136:139], v[148:151], v[64:79]
    s_waitcnt lgkmcnt(6)
    ds_read_b64_tr_b16 v[112:113], v156 offset:0
    ds_read_b64_tr_b16 v[114:115], v156 offset:1280
    s_sub_u32 s22, s22, 1
    s_cmp_lg_u32 s22, 0
    s_cbranch_scc1 P1_loop_P
    s_waitcnt lgkmcnt(0)
    s_nop 7
    s_nop 3
    s_cmp_eq_u32 s11, 3
    s_cbranch_scc1 P1_epiBq
    s_cmp_eq_u32 s11, 4
    s_cbranch_scc1 P1_epiBkv
P1_epiAQ:
    s_mul_i32 s14, s12, 196608
    s_mul_i32 s15, s10, 49152
    s_add_u32 s14, s14, s15
    s_mul_i32 s15, s13, 12288
    s_add_u32 s14, s14, s15
    s_add_u32 s14, s14, 0
    s_add_u32 s34, s4, s14
    s_addc_u32 s35, s5, 0
    v_mul_f32 v162, v0, v0
    v_mul_f32 v166, v20, v20
    v_mul_f32 v163, v12, v12
    v_mul_f32 v167, v32, v32
    v_mul_f32 v164, v8, v8
    v_mul_f32 v168, v28, v28
    v_fmac_f32 v162, v1, v1
    v_fmac_f32 v166, v21, v21
    v_fmac_f32 v163, v13, v13
    v_fmac_f32 v167, v33, v33
    v_fmac_f32 v164, v9, v9
    v_fmac_f32 v168, v29, v29
    v_fmac_f32 v162, v2, v2
    v_fmac_f32 v166, v22, v22
    v_fmac_f32 v163, v14, v14
    v_fmac_f32 v167, v34, v34
    v_fmac_f32 v164, v10, v10
    v_fmac_f32 v168, v30, v30
    v_fmac_f32 v162, v3, v3
    v_fmac_f32 v166, v23, v23
    v_fmac_f32 v163, v15, v15
    v_fmac_f32 v167, v35, v35
    v_fmac_f32 v164, v11, v11
    v_fmac_f32 v168, v31, v31
    v_fmac_f32 v162, v4, v4
    v_fmac_f32 v166, v24, v24
    v_fmac_f32 v163, v16, v16
    v_fmac_f32 v167, v36, v36
    v_fmac_f32 v162, v5, v5
    v_fmac_f32 v166, v25, v25
    v_fmac_f32 v163, v17, v17
    v_fmac_f32 v167, v37, v37
    v_fmac_f32 v162, v6, v6
    v_fmac_f32 v166, v26, v26
    v_fmac_f32 v163, v18, v18
    v_fmac_f32 v167, v38, v38
    v_fmac_f32 v162, v7, v7
    v_fmac_f32 v166, v27, v27
    v_fmac_f32 v163, v19, v19
    v_fmac_f32 v167, v39, v39
    v_cndmask_b32 v165, 0, v164, s[30:31]
    v_cndmask_b32 v169, 0, v168, s[30:31]
    v_add_f32 v162, v162, v165
    v_add_f32 v166, v166, v169
    v_cndmask_b32 v165, 0, v164, s[32:33]
    v_cndmask_b32 v169, 0, v168, s[32:33]
    v_add_f32 v163, v163, v165
    v_add_f32 v167, v167, v169
    v_cvt_pk_bf16_f32 v96, v0, v1
    v_cvt_pk_bf16_f32 v108, v20, v21
    v_cvt_pk_bf16_f32 v97, v2, v3
    v_cvt_pk_bf16_f32 v109, v22, v23
    v_cvt_pk_bf16_f32 v98, v4, v5
    v_cvt_pk_bf16_f32 v110, v24, v25
    v_cvt_pk_bf16_f32 v99, v6, v7
    v_cvt_pk_bf16_f32 v111, v26, v27
    v_permlane32_swap_b32 v163, v162
    v_permlane32_swap_b32 v167, v166
    v_cvt_pk_bf16_f32 v100, v12, v13
    v_cvt_pk_bf16_f32 v112, v32, v33
    v_cvt_pk_bf16_f32 v101, v14, v15
    v_cvt_pk_bf16_f32 v113, v34, v35
    v_cvt_pk_bf16_f32 v102, v16, v17
    v_cvt_pk_bf16_f32 v114, v36, v37
    v_cvt_pk_bf16_f32 v103, v18, v19
    v_cvt_pk_bf16_f32 v115, v38, v39
    v_add_f32 v163, v163, v162
    v_add_f32 v167, v167, v166
    v_cvt_pk_bf16_f32 v104, v8, v9
    v_cvt_pk_bf16_f32 v116, v28, v29
    v_sqrt_f32 v106, v163
    v_sqrt_f32 v118, v167
    v_cvt_pk_bf16_f32 v105, v10, v11
    v_cvt_pk_bf16_f32 v117, v30, v31
    v_mov_b32 v107, 0
    v_mov_b32 v119, 0
    global_store_dwordx4 v201, v[96:99], s[34:35] offset:0 sc1
    global_store_dwordx4 v201, v[100:103], s[34:35] offset:1024 sc1
    global_store_dwordx4 v201, v[104:107], s[34:35] offset:2048 sc1
    s_add_u32 s34, s34, 3072
    s_addc_u32 s35, s35, 0
    global_store_dwordx4 v201, v[108:111], s[34:35] offset:0 sc1
    global_store_dwordx4 v201, v[112:115], s[34:35] offset:1024 sc1
    global_store_dwordx4 v201, v[116:119], s[34:35] offset:2048 sc1
    s_add_u32 s34, s34, 3072
    s_addc_u32 s35, s35, 0
    s_sub_u32 s14, s11, 1
    s_cmp_lt_u32 s14, 2
    s_cbranch_scc0 P1_nokvsig
    s_waitcnt vmcnt(6)
    s_barrier
    s_cmp_eq_u32 s10, 2
    s_cbranch_scc0 P1_nokvsig
    s_lshl_b32 s15, s12, 1
    s_add_u32 s14, s14, s15
    s_lshl_b32 s14, s14, 7
    s_add_u32 s14, s14, 22070272
    v_lshlrev_b32 v224, 12, v200
    v_add_u32 v224, s14, v224
    v_mov_b32 v225, 1
    s_mov_b64 exec, 15
    global_store_dword v224, v225, s[4:5] sc1
    s_mov_b64 exec, -1
P1_nokvsig:
    v_mul_f32 v162, v40, v40
    v_mul_f32 v166, v60, v60
    v_mul_f32 v163, v52, v52
    v_mul_f32 v167, v72, v72
    v_mul_f32 v164, v48, v48
    v_mul_f32 v168, v68, v68
    v_fmac_f32 v162, v41, v41
    v_fmac_f32 v166, v61, v61
    v_fmac_f32 v163, v53, v53
    v_fmac_f32 v167, v73, v73
    v_fmac_f32 v164, v49, v49
    v_fmac_f32 v168, v69, v69
    v_fmac_f32 v162, v42, v42
    v_fmac_f32 v166, v62, v62
    v_fmac_f32 v163, v54, v54
    v_fmac_f32 v167, v74, v74
    v_fmac_f32 v164, v50, v50
    v_fmac_f32 v168, v70, v70
    v_fmac_f32 v162, v43, v43
    v_fmac_f32 v166, v63, v63
    v_fmac_f32 v163, v55, v55
    v_fmac_f32 v167, v75, v75
    v_fmac_f32 v164, v51, v51
    v_fmac_f32 v168, v71, v71
    v_fmac_f32 v162, v44, v44
    v_fmac_f32 v166, v64, v64
    v_fmac_f32 v163, v56, v56
    v_fmac_f32 v167, v76, v76
    v_fmac_f32 v162, v45, v45
    v_fmac_f32 v166, v65, v65
    v_fmac_f32 v163, v57, v57
    v_fmac_f32 v167, v77, v77
    v_fmac_f32 v162, v46, v46
    v_fmac_f32 v166, v66, v66
    v_fmac_f32 v163, v58, v58
    v_fmac_f32 v167, v78, v78
    v_fmac_f32 v162, v47, v47
    v_fmac_f32 v166, v67, v67
    v_fmac_f32 v163, v59, v59
    v_fmac_f32 v167, v79, v79
    v_cndmask_b32 v165, 0, v164, s[30:31]
    v_cndmask_b32 v169, 0, v168, s[30:31]
    v_add_f32 v162, v162, v165
    v_add_f32 v166, v166, v169
    v_cndmask_b32 v165, 0, v164, s[32:33]
    v_cndmask_b32 v169, 0, v168, s[32:33]
    v_add_f32 v163, v163, v165
    v_add_f32 v167, v167, v169
    v_cvt_pk_bf16_f32 v120, v40, v41
    v_cvt_pk_bf16_f32 v132, v60, v61
    v_cvt_pk_bf16_f32 v121, v42, v43
    v_cvt_pk_bf16_f32 v133, v62, v63
    v_cvt_pk_bf16_f32 v122, v44, v45
    v_cvt_pk_bf16_f32 v134, v64, v65
    v_cvt_pk_bf16_f32 v123, v46, v47
    v_cvt_pk_bf16_f32 v135, v66, v67
    v_permlane32_swap_b32 v163, v162
    v_permlane32_swap_b32 v167, v166
    v_cvt_pk_bf16_f32 v124, v52, v53
    v_cvt_pk_bf16_f32 v136, v72, v73
    v_cvt_pk_bf16_f32 v125, v54, v55
    v_cvt_pk_bf16_f32 v137, v74, v75
    v_cvt_pk_bf16_f32 v126, v56, v57
    v_cvt_pk_bf16_f32 v138, v76, v77
    v_cvt_pk_bf16_f32 v127, v58, v59
    v_cvt_pk_bf16_f32 v139, v78, v79
    v_add_f32 v163, v163, v162
    v_add_f32 v167, v167, v166
    v_cvt_pk_bf16_f32 v128, v48, v49
    v_cvt_pk_bf16_f32 v140, v68, v69
    v_sqrt_f32 v130, v163
    v_sqrt_f32 v142, v167
    v_cvt_pk_bf16_f32 v129, v50, v51
    v_cvt_pk_bf16_f32 v141, v70, v71
    v_mov_b32 v131, 0
    v_mov_b32 v143, 0
    global_store_dwordx4 v201, v[120:123], s[34:35] offset:0 sc1
    global_store_dwordx4 v201, v[124:127], s[34:35] offset:1024 sc1
    global_store_dwordx4 v201, v[128:131], s[34:35] offset:2048 sc1
    s_add_u32 s34, s34, 3072
    s_addc_u32 s35, s35, 0
    global_store_dwordx4 v201, v[132:135], s[34:35] offset:0 sc1
    global_store_dwordx4 v201, v[136:139], s[34:35] offset:1024 sc1
    global_store_dwordx4 v201, v[140:143], s[34:35] offset:2048 sc1
    s_branch P1_fin
P1_mainK:
    s_barrier
    ds_read_b128 v[144:147], v158
    ds_read_b64_tr_b16 v[96:97], v152
    ds_read_b64_tr_b16 v[98:99], v152 offset:1280
    ds_read_b64_tr_b16 v[100:101], v153
    ds_read_b64_tr_b16 v[102:103], v153 offset:1280
    ds_read_b64_tr_b16 v[104:105], v154
    ds_read_b64_tr_b16 v[106:107], v154 offset:1280
    ds_read_b64_tr_b16 v[108:109], v155
    ds_read_b64_tr_b16 v[110:111], v155 offset:1280
    ds_read_b64_tr_b16 v[112:113], v156
    ds_read_b64_tr_b16 v[114:115], v156 offset:1280
    ds_read_b64_tr_b16 v[116:117], v157
    ds_read_b64_tr_b16 v[118:119], v157 offset:160
    s_mov_b32 s22, 10
    s_mov_b32 s27, 0
    s_mov_b32 s40, 36864
    s_mov_b32 s41, 2560
    s_waitcnt lgkmcnt(10)
.p2align 6
P1_loop_K:
    s_cmp_eq_u32 s27, 3
    s_cselect_b32 s26, 4294856704, s40
    s_cselect_b32 s29, 4294959616, s41
    s_add_u32 s27, s27, 1
    s_and_b32 s27, s27, 3
    v_mfma_f32_32x32x16_bf16 v[0:15], v[96:99], v[144:147], v[0:15]
    s_waitcnt lgkmcnt(8)
    ds_read_b128 v[148:151], v159
    ds_read_b64_tr_b16 v[120:121], v152 offset:5120
    ds_read_b64_tr_b16 v[122:123], v152 offset:6400
    v_mfma_f32_32x32x16_bf16 v[16:31], v[100:103], v[144:147], v[16:31]
    s_waitcnt lgkmcnt(9)
    ds_read_b64_tr_b16 v[124:125], v153 offset:5120
    ds_read_b64_tr_b16 v[126:127], v153 offset:6400
    v_mfma_f32_32x32x16_bf16 v[32:47], v[104:107], v[144:147], v[32:47]
    s_waitcnt lgkmcnt(9)
    ds_read_b64_tr_b16 v[128:129], v154 offset:5120
    ds_read_b64_tr_b16 v[130:131], v154 offset:6400
    v_mfma_f32_32x32x16_bf16 v[48:63], v[108:111], v[144:147], v[48:63]
    s_waitcnt lgkmcnt(9)
    ds_read_b64_tr_b16 v[132:133], v155 offset:5120
    ds_read_b64_tr_b16 v[134:135], v155 offset:6400
    v_mfma_f32_32x32x16_bf16 v[64:79], v[112:115], v[144:147], v[64:79]
    s_waitcnt lgkmcnt(9)
    ds_read_b64_tr_b16 v[136:137], v156 offset:5120
    ds_read_b64_tr_b16 v[138:139], v156 offset:6400
    v_mfma_f32_32x32x16_bf16 v[80:95], v[116:119], v[144:147], v[80:95]
    s_waitcnt lgkmcnt(8)
    ds_read_b64_tr_b16 v[140:141], v157 offset:640
    ds_read_b64_tr_b16 v[142:143], v157 offset:800
    v_mfma_f32_32x32x16_bf16 v[0:15], v[120:123], v[148:151], v[0:15]
    s_waitcnt lgkmcnt(8)
    ds_read_b128 v[144:147], v160
    ds_read_b64_tr_b16 v[96:97], v152 offset:10240
    ds_read_b64_tr_b16 v[98:99], v152 offset:11520
    v_mfma_f32_32x32x16_bf16 v[16:31], v[124:127], v[148:151], v[16:31]
    s_waitcnt lgkmcnt(9)
    ds_read_b64_tr_b16 v[100:101], v153 offset:10240
    ds_read_b64_tr_b16 v[102:103], v153 offset:11520
    v_mfma_f32_32x32x16_bf16 v[32:47], v[128:131], v[148:151], v[32:47]
    s_waitcnt lgkmcnt(9)
    ds_read_b64_tr_b16 v[104:105], v154 offset:10240
    ds_read_b64_tr_b16 v[106:107], v154 offset:11520
    v_mfma_f32_32x32x16_bf16 v[48:63], v[132:135], v[148:151], v[48:63]
    s_waitcnt lgkmcnt(9)
    ds_read_b64_tr_b16 v[108:109], v155 offset:10240
    ds_read_b64_tr_b16 v[110:111], v155 offset:11520
    v_mfma_f32_32x32x16_bf16 v[64:79], v[136:139], v[148:151], v[64:79]
    s_waitcnt lgkmcnt(9)
    ds_read_b64_tr_b16 v[112:113], v156 offset:10240
    ds_read_b64_tr_b16 v[114:115], v156 offset:11520
    v_mfma_f32_32x32x16_bf16 v[80:95], v[140:143], v[148:151], v[80:95]
    s_waitcnt lgkmcnt(8)
    ds_read_b64_tr_b16 v[116:117], v157 offset:1280
    ds_read_b64_tr_b16 v[118:119], v157 offset:1440
    v_mfma_f32_32x32x16_bf16 v[0:15], v[96:99], v[144:147], v[0:15]
    s_waitcnt lgkmcnt(8)
    ds_read_b128 v[148:151], v161
    ds_read_b64_tr_b16 v[120:121], v152 offset:15360
    ds_read_b64_tr_b16 v[122:123], v152 offset:16640
    v_mfma_f32_32x32x16_bf16 v[16:31], v[100:103], v[144:147], v[16:31]
    s_waitcnt lgkmcnt(9)
    ds_read_b64_tr_b16 v[124:125], v153 offset:15360
    ds_read_b64_tr_b16 v[126:127], v153 offset:16640
    v_mfma_f32_32x32x16_bf16 v[32:47], v[104:107], v[144:147], v[32:47]
    s_waitcnt lgkmcnt(9)
    ds_read_b64_tr_b16 v[128:129], v154 offset:15360
    ds_read_b64_tr_b16 v[130:131], v154 offset:16640
    v_mfma_f32_32x32x16_bf16 v[48:63], v[108:111], v[144:147], v[48:63]
    s_waitcnt lgkmcnt(9)
    ds_read_b64_tr_b16 v[132:133], v155 offset:15360
    ds_read_b64_tr_b16 v[134:135], v155 offset:16640
    v_mfma_f32_32x32x16_bf16 v[64:79], v[112:115], v[144:147], v[64:79]
    s_waitcnt lgkmcnt(9)
    ds_read_b64_tr_b16 v[136:137], v156 offset:15360
    ds_read_b64_tr_b16 v[138:139], v156 offset:16640
    v_mfma_f32_32x32x16_bf16 v[80:95], v[116:119], v[144:147], v[80:95]
    s_waitcnt lgkmcnt(8)
    ds_read_b64_tr_b16 v[140:141], v157 offset:1920
    ds_read_b64_tr_b16 v[142:143], v157 offset:2080
    v_mfma_f32_32x32x16_bf16 v[0:15], v[120:123], v[148:151], v[0:15]
    s_waitcnt lgkmcnt(8)
    s_barrier
    v_add_u32 v158, s26, v158
    v_add_u32 v159, s26, v159
    v_add_u32 v160, s26, v160
    v_add_u32 v161, s26, v161
    v_add_u32 v152, s26, v152
    v_add_u32 v153, s26, v153
    v_add_u32 v154, s26, v154
    v_add_u32 v155, s26, v155
    v_add_u32 v156, s26, v156
    v_add_u32 v157, s29, v157
    ds_read_b128 v[144:147], v158
    ds_read_b64_tr_b16 v[96:97], v152 offset:0
    ds_read_b64_tr_b16 v[98:99], v152 offset:1280
    v_mfma_f32_32x32x16_bf16 v[16:31], v[124:127], v[148:151], v[16:31]
    s_waitcnt lgkmcnt(9)
    ds_read_b64_tr_b16 v[100:101], v153 offset:0
    ds_read_b64_tr_b16 v[102:103], v153 offset:1280
    v_mfma_f32_32x32x16_bf16 v[32:47], v[128:131], v[148:151], v[32:47]
    s_waitcnt lgkmcnt(9)
    ds_read_b64_tr_b16 v[104:105], v154 offset:0
    ds_read_b64_tr_b16 v[106:107], v154 offset:1280
    v_mfma_f32_32x32x16_bf16 v[48:63], v[132:135], v[148:151], v[48:63]
    s_waitcnt lgkmcnt(9)
    ds_read_b64_tr_b16 v[108:109], v155 offset:0
    ds_read_b64_tr_b16 v[110:111], v155 offset:1280
    v_mfma_f32_32x32x16_bf16 v[64:79], v[136:139], v[148:151], v[64:79]
    s_waitcnt lgkmcnt(9)
    ds_read_b64_tr_b16 v[112:113], v156 offset:0
    ds_read_b64_tr_b16 v[114:115], v156 offset:1280
    v_mfma_f32_32x32x16_bf16 v[80:95], v[140:143], v[148:151], v[80:95]
    s_waitcnt lgkmcnt(8)
    ds_read_b64_tr_b16 v[116:117], v157 offset:0
    ds_read_b64_tr_b16 v[118:119], v157 offset:160
    s_sub_u32 s22, s22, 1
    s_cmp_lg_u32 s22, 0
    s_cbranch_scc1 P1_loop_K
    s_waitcnt lgkmcnt(0)
    s_nop 7
    s_nop 3
    s_mov_b32 s38, 1051011932
    v_mul_f32 v80, s38, v80
    v_mul_f32 v81, s38, v81
    v_mul_f32 v82, s38, v82
    v_mul_f32 v83, s38, v83
    v_mul_f32 v84, s38, v84
    v_mul_f32 v85, s38, v85
    v_mul_f32 v86, s38, v86
    v_mul_f32 v87, s38, v87
    v_mul_f32 v88, s38, v88
    v_mul_f32 v89, s38, v89
    v_mul_f32 v90, s38, v90
    v_mul_f32 v91, s38, v91
    v_mul_f32 v162, v80, v80
    v_mul_f32 v163, v88, v88
    v_fmac_f32 v162, v81, v81
    v_fmac_f32 v162, v82, v82
    v_fmac_f32 v162, v83, v83
    v_fmac_f32 v162, v84, v84
    v_fmac_f32 v162, v85, v85
    v_fmac_f32 v162, v86, v86
    v_fmac_f32 v162, v87, v87
    v_fmac_f32 v163, v89, v89
    v_fmac_f32 v163, v90, v90
    v_fmac_f32 v163, v91, v91
    v_cndmask_b32 v163, 0, v163, s[30:31]
    v_add_f32 v162, v162, v163
    v_cvt_pk_bf16_f32 v170, v80, v81
    v_cvt_pk_bf16_f32 v171, v82, v83
    v_cvt_pk_bf16_f32 v172, v84, v85
    v_cvt_pk_bf16_f32 v173, v86, v87
    v_mov_b32 v164, v162
    v_cvt_pk_bf16_f32 v92, v88, v89
    v_cvt_pk_bf16_f32 v93, v90, v91
    v_permlane32_swap_b32 v164, v162
    v_mov_b32 v94, 0x3f803f80
    v_mov_b32 v95, 0x3f80
    v_add_f32 v162, v162, v164
    v_cndmask_b32 v174, v94, v92, s[30:31]
    v_cndmask_b32 v175, v95, v93, s[30:31]
    v_cndmask_b32 v176, v94, v92, s[32:33]
    v_cndmask_b32 v177, v95, v93, s[32:33]
    s_mul_i32 s14, s12, 16384
    s_mul_i32 s15, s10, 4096
    s_add_u32 s14, s14, s15
    s_mul_i32 s15, s13, 0
    s_add_u32 s14, s14, s15
    s_add_u32 s14, s14, 4194304
    s_add_u32 s34, s4, s14
    s_addc_u32 s35, s5, 0
    global_store_dwordx4 v201, v[170:173], s[34:35] sc1
    global_store_dwordx4 v201, v[174:177], s[34:35] offset:1024 sc1
    v_max_f32_dpp v162, v162, v162 row_ror:8 row_mask:0xf bank_mask:0xf
    s_nop 1
    v_max_f32_dpp v162, v162, v162 row_ror:4 row_mask:0xf bank_mask:0xf
    s_nop 1
    v_max_f32_dpp v162, v162, v162 row_ror:2 row_mask:0xf bank_mask:0xf
    s_nop 1
    v_max_f32_dpp v162, v162, v162 row_ror:1 row_mask:0xf bank_mask:0xf
    s_nop 0
    v_readlane_b32 s38, v162, 0
    v_readlane_b32 s39, v162, 16
    s_mul_i32 s14, s12, 16
    s_mul_i32 s15, s10, 4
    s_add_u32 s14, s14, s15
    s_mul_i32 s15, s13, 0
    s_add_u32 s14, s14, s15
    s_add_u32 s14, s14, 4718592
    s_add_u32 s34, s4, s14
    s_addc_u32 s35, s5, 0
    s_max_u32 s38, s38, s39
    v_mov_b32 v164, s38
    v_mov_b32 v165, 0
    s_mov_b64 exec, 1
    global_store_dword v165, v164, s[34:35] sc1
    s_mov_b64 exec, -1
    s_branch P1_epiAQ
P1_mainV:
    s_barrier
    ds_read_b128 v[144:147], v158
    ds_read_b64_tr_b16 v[96:97], v152
    ds_read_b64_tr_b16 v[98:99], v152 offset:1280
    ds_read_b64_tr_b16 v[100:101], v153
    ds_read_b64_tr_b16 v[102:103], v153 offset:1280
    ds_read_b64_tr_b16 v[104:105], v154
    ds_read_b64_tr_b16 v[106:107], v154 offset:1280
    ds_read_b64_tr_b16 v[108:109], v155
    ds_read_b64_tr_b16 v[110:111], v155 offset:1280
    ds_read_b64_tr_b16 v[112:113], v156
    ds_read_b64_tr_b16 v[114:115], v156 offset:1280
    ds_read_b64_tr_b16 v[116:117], v157
    ds_read_b64_tr_b16 v[118:119], v157 offset:160
    s_mov_b32 s22, 10
    s_mov_b32 s27, 0
    s_mov_b32 s40, 36864
    s_mov_b32 s41, 2560
    s_waitcnt lgkmcnt(10)
.p2align 6
P1_loop_V:
    s_cmp_eq_u32 s27, 3
    s_cselect_b32 s26, 4294856704, s40
    s_cselect_b32 s29, 4294959616, s41
    s_add_u32 s27, s27, 1
    s_and_b32 s27, s27, 3
    v_mfma_f32_32x32x16_bf16 v[0:15], v[96:99], v[144:147], v[0:15]
    s_waitcnt lgkmcnt(8)
    ds_read_b128 v[148:151], v159
    ds_read_b64_tr_b16 v[120:121], v152 offset:5120
    ds_read_b64_tr_b16 v[122:123], v152 offset:6400
    v_mfma_f32_32x32x16_bf16 v[16:31], v[100:103], v[144:147], v[16:31]
    s_waitcnt lgkmcnt(9)
    ds_read_b64_tr_b16 v[124:125], v153 offset:5120
    ds_read_b64_tr_b16 v[126:127], v153 offset:6400
    v_mfma_f32_32x32x16_bf16 v[32:47], v[104:107], v[144:147], v[32:47]
    s_waitcnt lgkmcnt(9)
    ds_read_b64_tr_b16 v[128:129], v154 offset:5120
    ds_read_b64_tr_b16 v[130:131], v154 offset:6400
    v_mfma_f32_32x32x16_bf16 v[48:63], v[108:111], v[144:147], v[48:63]
    s_waitcnt lgkmcnt(9)
    ds_read_b64_tr_b16 v[132:133], v155 offset:5120
    ds_read_b64_tr_b16 v[134:135], v155 offset:6400
    v_mfma_f32_32x32x16_bf16 v[64:79], v[112:115], v[144:147], v[64:79]
    s_waitcnt lgkmcnt(9)
    ds_read_b64_tr_b16 v[136:137], v156 offset:5120
    ds_read_b64_tr_b16 v[138:139], v156 offset:6400
    v_mfma_f32_32x32x16_bf16 v[80:95], v[144:147], v[116:119], v[80:95]
    s_waitcnt lgkmcnt(8)
    ds_read_b64_tr_b16 v[140:141], v157 offset:640
    ds_read_b64_tr_b16 v[142:143], v157 offset:800
    v_mfma_f32_32x32x16_bf16 v[0:15], v[120:123], v[148:151], v[0:15]
    s_waitcnt lgkmcnt(8)
    ds_read_b128 v[144:147], v160
    ds_read_b64_tr_b16 v[96:97], v152 offset:10240
    ds_read_b64_tr_b16 v[98:99], v152 offset:11520
    v_mfma_f32_32x32x16_bf16 v[16:31], v[124:127], v[148:151], v[16:31]
    s_waitcnt lgkmcnt(9)
    ds_read_b64_tr_b16 v[100:101], v153 offset:10240
    ds_read_b64_tr_b16 v[102:103], v153 offset:11520
    v_mfma_f32_32x32x16_bf16 v[32:47], v[128:131], v[148:151], v[32:47]
    s_waitcnt lgkmcnt(9)
    ds_read_b64_tr_b16 v[104:105], v154 offset:10240
    ds_read_b64_tr_b16 v[106:107], v154 offset:11520
    v_mfma_f32_32x32x16_bf16 v[48:63], v[132:135], v[148:151], v[48:63]
    s_waitcnt lgkmcnt(9)
    ds_read_b64_tr_b16 v[108:109], v155 offset:10240
    ds_read_b64_tr_b16 v[110:111], v155 offset:11520
    v_mfma_f32_32x32x16_bf16 v[64:79], v[136:139], v[148:151], v[64:79]
    s_waitcnt lgkmcnt(9)
    ds_read_b64_tr_b16 v[112:113], v156 offset:10240
    ds_read_b64_tr_b16 v[114:115], v156 offset:11520
    v_mfma_f32_32x32x16_bf16 v[80:95], v[148:151], v[140:143], v[80:95]
    s_waitcnt lgkmcnt(8)
    ds_read_b64_tr_b16 v[116:117], v157 offset:1280
    ds_read_b64_tr_b16 v[118:119], v157 offset:1440
    v_mfma_f32_32x32x16_bf16 v[0:15], v[96:99], v[144:147], v[0:15]
    s_waitcnt lgkmcnt(8)
    ds_read_b128 v[148:151], v161
    ds_read_b64_tr_b16 v[120:121], v152 offset:15360
    ds_read_b64_tr_b16 v[122:123], v152 offset:16640
    v_mfma_f32_32x32x16_bf16 v[16:31], v[100:103], v[144:147], v[16:31]
    s_waitcnt lgkmcnt(9)
    ds_read_b64_tr_b16 v[124:125], v153 offset:15360
    ds_read_b64_tr_b16 v[126:127], v153 offset:16640
    v_mfma_f32_32x32x16_bf16 v[32:47], v[104:107], v[144:147], v[32:47]
    s_waitcnt lgkmcnt(9)
    ds_read_b64_tr_b16 v[128:129], v154 offset:15360
    ds_read_b64_tr_b16 v[130:131], v154 offset:16640
    v_mfma_f32_32x32x16_bf16 v[48:63], v[108:111], v[144:147], v[48:63]
    s_waitcnt lgkmcnt(9)
    ds_read_b64_tr_b16 v[132:133], v155 offset:15360
    ds_read_b64_tr_b16 v[134:135], v155 offset:16640
    v_mfma_f32_32x32x16_bf16 v[64:79], v[112:115], v[144:147], v[64:79]
    s_waitcnt lgkmcnt(9)
    ds_read_b64_tr_b16 v[136:137], v156 offset:15360
    ds_read_b64_tr_b16 v[138:139], v156 offset:16640
    v_mfma_f32_32x32x16_bf16 v[80:95], v[144:147], v[116:119], v[80:95]
    s_waitcnt lgkmcnt(8)
    ds_read_b64_tr_b16 v[140:141], v157 offset:1920
    ds_read_b64_tr_b16 v[142:143], v157 offset:2080
    v_mfma_f32_32x32x16_bf16 v[0:15], v[120:123], v[148:151], v[0:15]
    s_waitcnt lgkmcnt(8)
    s_barrier
    v_add_u32 v158, s26, v158
    v_add_u32 v159, s26, v159
    v_add_u32 v160, s26, v160
    v_add_u32 v161, s26, v161
    v_add_u32 v152, s26, v152
    v_add_u32 v153, s26, v153
    v_add_u32 v154, s26, v154
    v_add_u32 v155, s26, v155
    v_add_u32 v156, s26, v156
    v_add_u32 v157, s29, v157
    ds_read_b128 v[144:147], v158
    ds_read_b64_tr_b16 v[96:97], v152 offset:0
    ds_read_b64_tr_b16 v[98:99], v152 offset:1280
    v_mfma_f32_32x32x16_bf16 v[16:31], v[124:127], v[148:151], v[16:31]
    s_waitcnt lgkmcnt(9)
    ds_read_b64_tr_b16 v[100:101], v153 offset:0
    ds_read_b64_tr_b16 v[102:103], v153 offset:1280
    v_mfma_f32_32x32x16_bf16 v[32:47], v[128:131], v[148:151], v[32:47]
    s_waitcnt lgkmcnt(9)
    ds_read_b64_tr_b16 v[104:105], v154 offset:0
    ds_read_b64_tr_b16 v[106:107], v154 offset:1280
    v_mfma_f32_32x32x16_bf16 v[48:63], v[132:135], v[148:151], v[48:63]
    s_waitcnt lgkmcnt(9)
    ds_read_b64_tr_b16 v[108:109], v155 offset:0
    ds_read_b64_tr_b16 v[110:111], v155 offset:1280
    v_mfma_f32_32x32x16_bf16 v[64:79], v[136:139], v[148:151], v[64:79]
    s_waitcnt lgkmcnt(9)
    ds_read_b64_tr_b16 v[112:113], v156 offset:0
    ds_read_b64_tr_b16 v[114:115], v156 offset:1280
    v_mfma_f32_32x32x16_bf16 v[80:95], v[148:151], v[140:143], v[80:95]
    s_waitcnt lgkmcnt(8)
    ds_read_b64_tr_b16 v[116:117], v157 offset:0
    ds_read_b64_tr_b16 v[118:119], v157 offset:160
    s_sub_u32 s22, s22, 1
    s_cmp_lg_u32 s22, 0
    s_cbranch_scc1 P1_loop_V
    s_waitcnt lgkmcnt(0)
    s_nop 7
    s_nop 3
    v_and_b32 v162, 31, v200
    v_cmp_eq_u32 vcc, 20, v162
    v_mov_b32 v164, 0x3f803f80
    v_cvt_pk_bf16_f32 v170, v80, v81
    v_cvt_pk_bf16_f32 v171, v82, v83
    v_cvt_pk_bf16_f32 v172, v84, v85
    v_cvt_pk_bf16_f32 v173, v86, v87
    v_cvt_pk_bf16_f32 v174, v88, v89
    v_cvt_pk_bf16_f32 v175, v90, v91
    v_cvt_pk_bf16_f32 v176, v92, v93
    v_cvt_pk_bf16_f32 v177, v94, v95
    v_cndmask_b32 v163, 0, v164, vcc
    v_cmp_gt_u32 vcc, 20, v162
    s_nop 1
    v_cndmask_b32 v170, v163, v170, vcc
    v_cndmask_b32 v171, v163, v171, vcc
    v_cndmask_b32 v172, v163, v172, vcc
    v_cndmask_b32 v173, v163, v173, vcc
    v_cndmask_b32 v174, v163, v174, vcc
    v_cndmask_b32 v175, v163, v175, vcc
    v_cndmask_b32 v176, v163, v176, vcc
    v_cndmask_b32 v177, v163, v177, vcc
    s_mul_i32 s14, s12, 16384
    s_mul_i32 s15, s10, 4096
    s_add_u32 s14, s14, s15
    s_mul_i32 s15, s13, 0
    s_add_u32 s14, s14, s15
    s_add_u32 s14, s14, 4196352
    s_add_u32 s34, s4, s14
    s_addc_u32 s35, s5, 0
    global_store_dwordx4 v201, v[170:173], s[34:35] sc1
    global_store_dwordx4 v201, v[174:177], s[34:35] offset:1024 sc1
    s_branch P1_epiAQ
P1_epiBq:
    v_bfe_u32 v190, v200, 4, 1
    v_lshlrev_b32 v190, 2, v190
    v_and_b32 v191, 3, v200
    v_add_u32 v190, v190, v191
    v_min_u32 v190, 4, v190
    v_lshlrev_b32 v190, 3, v190
    v_bfe_u32 v191, v200, 2, 2
    v_mul_u32_u24 v191, 40, v191
    v_add_u32 v190, v190, v191
    v_add_u32 v189, 148096, v190
    v_lshrrev_b32 v191, 5, v200
    v_mul_u32_u24 v191, 160, v191
    v_add_u32 v190, v190, v191
    v_add_u32 v188, 147456, v190
    ds_read_b64_tr_b16 v[164:165], v188 offset:0
    ds_read_b64_tr_b16 v[166:167], v188 offset:320
    ds_read_b64_tr_b16 v[168:169], v189 offset:0
    ds_read_b64_tr_b16 v[170:171], v188 offset:800
    ds_read_b64_tr_b16 v[172:173], v188 offset:1120
    ds_read_b64_tr_b16 v[174:175], v189 offset:800
    v_cvt_pk_bf16_f32 v96, v0, v1
    v_cvt_pk_bf16_f32 v97, v2, v3
    v_cvt_pk_bf16_f32 v98, v4, v5
    v_cvt_pk_bf16_f32 v99, v6, v7
    v_cvt_pk_bf16_f32 v100, v12, v13
    v_cvt_pk_bf16_f32 v101, v14, v15
    v_cvt_pk_bf16_f32 v102, v16, v17
    v_cvt_pk_bf16_f32 v103, v18, v19
    v_cvt_pk_bf16_f32 v104, v8, v9
    v_cvt_pk_bf16_f32 v105, v10, v11
    v_cvt_pk_bf16_f32 v106, v20, v21
    v_cvt_pk_bf16_f32 v107, v22, v23
    v_cvt_pk_bf16_f32 v108, v24, v25
    v_cvt_pk_bf16_f32 v109, v26, v27
    v_cvt_pk_bf16_f32 v110, v32, v33
    v_cvt_pk_bf16_f32 v111, v34, v35
    v_cvt_pk_bf16_f32 v112, v36, v37
    v_cvt_pk_bf16_f32 v113, v38, v39
    v_cvt_pk_bf16_f32 v114, v28, v29
    v_cvt_pk_bf16_f32 v115, v30, v31
    v_cvt_pk_bf16_f32 v116, v40, v41
    v_cvt_pk_bf16_f32 v117, v42, v43
    v_cvt_pk_bf16_f32 v118, v44, v45
    v_cvt_pk_bf16_f32 v119, v46, v47
    v_cvt_pk_bf16_f32 v120, v52, v53
    v_cvt_pk_bf16_f32 v121, v54, v55
    v_cvt_pk_bf16_f32 v122, v56, v57
    v_cvt_pk_bf16_f32 v123, v58, v59
    v_cvt_pk_bf16_f32 v124, v48, v49
    v_cvt_pk_bf16_f32 v125, v50, v51
    v_cvt_pk_bf16_f32 v126, v60, v61
    v_cvt_pk_bf16_f32 v127, v62, v63
    v_cvt_pk_bf16_f32 v128, v64, v65
    v_cvt_pk_bf16_f32 v129, v66, v67
    v_cvt_pk_bf16_f32 v130, v72, v73
    v_cvt_pk_bf16_f32 v131, v74, v75
    v_cvt_pk_bf16_f32 v132, v76, v77
    v_cvt_pk_bf16_f32 v133, v78, v79
    v_cvt_pk_bf16_f32 v134, v68, v69
    v_cvt_pk_bf16_f32 v135, v70, v71
    s_mov_b32 s38, 1069066811
    s_mov_b32 s39, 3216550459
    s_mul_i32 s14, s12, 327680
    s_mul_i32 s15, s10, 81920
    s_add_u32 s14, s14, s15
    s_mul_i32 s15, s13, 20480
    s_add_u32 s14, s14, s15
    s_add_u32 s14, s14, 11534336
    s_add_u32 s34, s4, s14
    s_addc_u32 s35, s5, 0
    v_add_u32 v202, 3072, v201
    s_waitcnt lgkmcnt(0)
    v_cndmask_b32 v168, 0, v168, s[30:31]
    v_cndmask_b32 v169, 0, v169, s[30:31]
    v_cndmask_b32 v174, 0, v174, s[32:33]
    v_cndmask_b32 v175, 0, v175, s[32:33]
    v_mfma_f32_32x32x16_bf16 v[0:15], v[164:167], v[96:99], 0
    v_mfma_f32_32x32x16_bf16 v[16:31], v[170:173], v[100:103], 0
    v_mfma_f32_32x32x8_bf16 v[0:15], v[168:169], v[104:105], v[0:15]
    v_mfma_f32_32x32x8_bf16 v[16:31], v[174:175], v[104:105], v[16:31]
    ds_read_b64_tr_b16 v[176:177], v188 offset:1600
    ds_read_b64_tr_b16 v[178:179], v188 offset:1920
    ds_read_b64_tr_b16 v[180:181], v189 offset:1600
    ds_read_b64_tr_b16 v[182:183], v188 offset:2400
    ds_read_b64_tr_b16 v[184:185], v188 offset:2720
    ds_read_b64_tr_b16 v[186:187], v189 offset:2400
    s_waitcnt lgkmcnt(0)
    v_cndmask_b32 v180, 0, v180, s[30:31]
    v_cndmask_b32 v181, 0, v181, s[30:31]
    v_cndmask_b32 v186, 0, v186, s[32:33]
    v_cndmask_b32 v187, 0, v187, s[32:33]
    v_mfma_f32_32x32x16_bf16 v[32:47], v[176:179], v[106:109], 0
    v_mfma_f32_32x32x16_bf16 v[48:63], v[182:185], v[110:113], 0
    v_mfma_f32_32x32x8_bf16 v[32:47], v[180:181], v[114:115], v[32:47]
    v_mfma_f32_32x32x8_bf16 v[48:63], v[186:187], v[114:115], v[48:63]
    v_cndmask_b32 v8, v8, v10, s[32:33]
    v_cndmask_b32 v24, v24, v26, s[32:33]
    v_cndmask_b32 v9, v9, v11, s[32:33]
    v_cndmask_b32 v25, v25, v27, s[32:33]
    v_max3_f32 v190, v0, v1, v2
    v_max3_f32 v206, v16, v17, v18
    v_max3_f32 v191, -v0, -v1, -v2
    v_max3_f32 v207, -v16, -v17, -v18
    v_max3_f32 v190, v190, v3, v4
    v_max3_f32 v206, v206, v19, v20
    v_max3_f32 v191, v191, -v3, -v4
    v_max3_f32 v207, v207, -v19, -v20
    v_max3_f32 v190, v190, v5, v6
    v_max3_f32 v206, v206, v21, v22
    v_max3_f32 v191, v191, -v5, -v6
    v_max3_f32 v207, v207, -v21, -v22
    v_max3_f32 v190, v190, v7, v8
    v_max3_f32 v206, v206, v23, v24
    v_max3_f32 v191, v191, -v7, -v8
    v_max3_f32 v207, v207, -v23, -v24
    v_max_f32 v190, v190, v9
    v_max_f32 v206, v206, v25
    v_max_f32 v191, v191, -v9
    v_max_f32 v207, v207, -v25
    s_nop 0
    v_permlane32_swap_b32 v190, v191
    v_permlane32_swap_b32 v206, v207
    v_max_f32 v190, v190, v191
    v_max_f32 v206, v206, v207
    v_mul_f32 v190, s39, v190
    v_mul_f32 v206, s39, v206
    v_mov_b32 v191, v190
    v_mov_b32 v207, v206
    s_nop 0
    v_permlane32_swap_b32 v190, v191
    v_permlane32_swap_b32 v206, v207
    v_fma_f32 v64, v0, s38, v190
    v_fma_f32 v136, v16, s38, v206
    v_fma_f32 v74, v0, s39, v191
    v_fma_f32 v146, v16, s39, v207
    v_fma_f32 v65, v1, s38, v190
    v_fma_f32 v137, v17, s38, v206
    v_fma_f32 v75, v1, s39, v191
    v_fma_f32 v147, v17, s39, v207
    v_fma_f32 v66, v2, s38, v190
    v_fma_f32 v138, v18, s38, v206
    v_fma_f32 v76, v2, s39, v191
    v_fma_f32 v148, v18, s39, v207
    v_fma_f32 v67, v3, s38, v190
    v_fma_f32 v139, v19, s38, v206
    v_fma_f32 v77, v3, s39, v191
    v_fma_f32 v149, v19, s39, v207
    v_fma_f32 v68, v4, s38, v190
    v_fma_f32 v140, v20, s38, v206
    v_fma_f32 v78, v4, s39, v191
    v_fma_f32 v150, v20, s39, v207
    v_fma_f32 v69, v5, s38, v190
    v_fma_f32 v141, v21, s38, v206
    v_fma_f32 v79, v5, s39, v191
    v_fma_f32 v151, v21, s39, v207
    v_fma_f32 v70, v6, s38, v190
    v_fma_f32 v142, v22, s38, v206
    v_fma_f32 v80, v6, s39, v191
    v_fma_f32 v152, v22, s39, v207
    v_fma_f32 v71, v7, s38, v190
    v_fma_f32 v143, v23, s38, v206
    v_fma_f32 v81, v7, s39, v191
    v_fma_f32 v153, v23, s39, v207
    v_fma_f32 v72, v8, s38, v190
    v_fma_f32 v144, v24, s38, v206
    v_fma_f32 v82, v8, s39, v191
    v_fma_f32 v154, v24, s39, v207
    v_fma_f32 v73, v9, s38, v190
    v_fma_f32 v145, v25, s38, v206
    v_fma_f32 v83, v9, s39, v191
    v_fma_f32 v155, v25, s39, v207
    v_exp_f32 v64, v64
    v_exp_f32 v136, v136
    v_exp_f32 v74, v74
    v_exp_f32 v146, v146
    v_exp_f32 v65, v65
    v_exp_f32 v137, v137
    v_exp_f32 v75, v75
    v_exp_f32 v147, v147
    v_exp_f32 v66, v66
    v_exp_f32 v138, v138
    v_exp_f32 v76, v76
    v_exp_f32 v148, v148
    v_exp_f32 v67, v67
    v_exp_f32 v139, v139
    v_exp_f32 v77, v77
    v_exp_f32 v149, v149
    v_exp_f32 v68, v68
    v_exp_f32 v140, v140
    v_exp_f32 v78, v78
    v_exp_f32 v150, v150
    v_exp_f32 v69, v69
    v_exp_f32 v141, v141
    v_exp_f32 v79, v79
    v_exp_f32 v151, v151
    v_exp_f32 v70, v70
    v_exp_f32 v142, v142
    v_exp_f32 v80, v80
    v_exp_f32 v152, v152
    v_exp_f32 v71, v71
    v_exp_f32 v143, v143
    v_exp_f32 v81, v81
    v_exp_f32 v153, v153
    v_exp_f32 v72, v72
    v_exp_f32 v144, v144
    v_exp_f32 v82, v82
    v_exp_f32 v154, v154
    v_exp_f32 v73, v73
    v_exp_f32 v145, v145
    v_exp_f32 v83, v83
    v_exp_f32 v155, v155
    v_pk_add_f32 v[194:195], v[64:65], v[66:67]
    v_pk_add_f32 v[210:211], v[136:137], v[138:139]
    v_pk_add_f32 v[196:197], v[74:75], v[76:77]
    v_pk_add_f32 v[212:213], v[146:147], v[148:149]
    v_pk_add_f32 v[194:195], v[194:195], v[68:69]
    v_pk_add_f32 v[210:211], v[210:211], v[140:141]
    v_pk_add_f32 v[196:197], v[196:197], v[78:79]
    v_pk_add_f32 v[212:213], v[212:213], v[150:151]
    v_pk_add_f32 v[194:195], v[194:195], v[70:71]
    v_pk_add_f32 v[210:211], v[210:211], v[142:143]
    v_pk_add_f32 v[196:197], v[196:197], v[80:81]
    v_pk_add_f32 v[212:213], v[212:213], v[152:153]
    v_pk_add_f32 v[194:195], v[194:195], v[72:73]
    v_pk_add_f32 v[210:211], v[210:211], v[144:145]
    v_pk_add_f32 v[196:197], v[196:197], v[82:83]
    v_pk_add_f32 v[212:213], v[212:213], v[154:155]
    v_add_f32 v190, v194, v195
    v_add_f32 v206, v210, v211
    v_add_f32 v191, v196, v197
    v_add_f32 v207, v212, v213
    s_nop 0
    v_permlane32_swap_b32 v190, v191
    v_permlane32_swap_b32 v206, v207
    v_add_f32 v190, v190, v191
    v_add_f32 v206, v206, v207
    v_rcp_f32 v192, v190
    v_rcp_f32 v208, v206
    v_mov_b32 v193, v192
    v_mov_b32 v209, v208
    s_nop 0
    v_permlane32_swap_b32 v192, v193
    v_permlane32_swap_b32 v208, v209
    v_pk_mul_f32 v[64:65], v[64:65], v[192:193] op_sel_hi:[1,0]
    v_pk_mul_f32 v[136:137], v[136:137], v[208:209] op_sel_hi:[1,0]
    v_pk_mul_f32 v[74:75], v[74:75], v[192:193] op_sel:[0,1] op_sel_hi:[1,1]
    v_pk_mul_f32 v[146:147], v[146:147], v[208:209] op_sel:[0,1] op_sel_hi:[1,1]
    v_pk_mul_f32 v[66:67], v[66:67], v[192:193] op_sel_hi:[1,0]
    v_pk_mul_f32 v[138:139], v[138:139], v[208:209] op_sel_hi:[1,0]
    v_pk_mul_f32 v[76:77], v[76:77], v[192:193] op_sel:[0,1] op_sel_hi:[1,1]
    v_pk_mul_f32 v[148:149], v[148:149], v[208:209] op_sel:[0,1] op_sel_hi:[1,1]
    v_pk_mul_f32 v[68:69], v[68:69], v[192:193] op_sel_hi:[1,0]
    v_pk_mul_f32 v[140:141], v[140:141], v[208:209] op_sel_hi:[1,0]
    v_pk_mul_f32 v[78:79], v[78:79], v[192:193] op_sel:[0,1] op_sel_hi:[1,1]
    v_pk_mul_f32 v[150:151], v[150:151], v[208:209] op_sel:[0,1] op_sel_hi:[1,1]
    v_pk_mul_f32 v[70:71], v[70:71], v[192:193] op_sel_hi:[1,0]
    v_pk_mul_f32 v[142:143], v[142:143], v[208:209] op_sel_hi:[1,0]
    v_pk_mul_f32 v[80:81], v[80:81], v[192:193] op_sel:[0,1] op_sel_hi:[1,1]
    v_pk_mul_f32 v[152:153], v[152:153], v[208:209] op_sel:[0,1] op_sel_hi:[1,1]
    v_pk_mul_f32 v[72:73], v[72:73], v[192:193] op_sel_hi:[1,0]
    v_pk_mul_f32 v[144:145], v[144:145], v[208:209] op_sel_hi:[1,0]
    v_pk_mul_f32 v[82:83], v[82:83], v[192:193] op_sel:[0,1] op_sel_hi:[1,1]
    v_pk_mul_f32 v[154:155], v[154:155], v[208:209] op_sel:[0,1] op_sel_hi:[1,1]
    v_cvt_pk_bf16_f32 v84, v64, v65
    v_cvt_pk_bf16_f32 v156, v136, v137
    v_cvt_pk_bf16_f32 v89, v74, v75
    v_cvt_pk_bf16_f32 v161, v146, v147
    v_cvt_pk_bf16_f32 v85, v66, v67
    v_cvt_pk_bf16_f32 v157, v138, v139
    v_cvt_pk_bf16_f32 v90, v76, v77
    v_cvt_pk_bf16_f32 v162, v148, v149
    v_cvt_pk_bf16_f32 v86, v68, v69
    v_cvt_pk_bf16_f32 v158, v140, v141
    v_cvt_pk_bf16_f32 v91, v78, v79
    v_cvt_pk_bf16_f32 v163, v150, v151
    v_cvt_pk_bf16_f32 v87, v70, v71
    v_cvt_pk_bf16_f32 v159, v142, v143
    v_cvt_pk_bf16_f32 v92, v80, v81
    v_cvt_pk_bf16_f32 v94, v152, v153
    v_cvt_pk_bf16_f32 v88, v72, v73
    v_cvt_pk_bf16_f32 v160, v144, v145
    v_cvt_pk_bf16_f32 v93, v82, v83
    v_cvt_pk_bf16_f32 v95, v154, v155
    global_store_dwordx4 v201, v[84:87], s[34:35] sc1
    global_store_dwordx4 v201, v[88:91], s[34:35] offset:1024 sc1
    global_store_dwordx4 v201, v[156:159], s[34:35] offset:2048 sc1
    global_store_dwordx4 v201, v[160:163], s[34:35] offset:3072 sc1
    global_store_dwordx4 v202, v[92:95], s[34:35] offset:1024 sc1
    s_add_u32 s34, s34, 5120
    s_addc_u32 s35, s35, 0
    ds_read_b64_tr_b16 v[164:165], v188 offset:3200
    ds_read_b64_tr_b16 v[166:167], v188 offset:3520
    ds_read_b64_tr_b16 v[168:169], v189 offset:3200
    ds_read_b64_tr_b16 v[170:171], v188 offset:4000
    ds_read_b64_tr_b16 v[172:173], v188 offset:4320
    ds_read_b64_tr_b16 v[174:175], v189 offset:4000
    s_waitcnt lgkmcnt(0)
    v_cndmask_b32 v168, 0, v168, s[30:31]
    v_cndmask_b32 v169, 0, v169, s[30:31]
    v_cndmask_b32 v174, 0, v174, s[32:33]
    v_cndmask_b32 v175, 0, v175, s[32:33]
    v_mfma_f32_32x32x16_bf16 v[0:15], v[164:167], v[116:119], 0
    v_mfma_f32_32x32x16_bf16 v[16:31], v[170:173], v[120:123], 0
    v_mfma_f32_32x32x8_bf16 v[0:15], v[168:169], v[124:125], v[0:15]
    v_mfma_f32_32x32x8_bf16 v[16:31], v[174:175], v[124:125], v[16:31]
    v_cndmask_b32 v40, v40, v42, s[32:33]
    v_cndmask_b32 v56, v56, v58, s[32:33]
    v_cndmask_b32 v41, v41, v43, s[32:33]
    v_cndmask_b32 v57, v57, v59, s[32:33]
    v_max3_f32 v190, v32, v33, v34
    v_max3_f32 v206, v48, v49, v50
    v_max3_f32 v191, -v32, -v33, -v34
    v_max3_f32 v207, -v48, -v49, -v50
    v_max3_f32 v190, v190, v35, v36
    v_max3_f32 v206, v206, v51, v52
    v_max3_f32 v191, v191, -v35, -v36
    v_max3_f32 v207, v207, -v51, -v52
    v_max3_f32 v190, v190, v37, v38
    v_max3_f32 v206, v206, v53, v54
    v_max3_f32 v191, v191, -v37, -v38
    v_max3_f32 v207, v207, -v53, -v54
    v_max3_f32 v190, v190, v39, v40
    v_max3_f32 v206, v206, v55, v56
    v_max3_f32 v191, v191, -v39, -v40
    v_max3_f32 v207, v207, -v55, -v56
    v_max_f32 v190, v190, v41
    v_max_f32 v206, v206, v57
    v_max_f32 v191, v191, -v41
    v_max_f32 v207, v207, -v57
    s_nop 0
    v_permlane32_swap_b32 v190, v191
    v_permlane32_swap_b32 v206, v207
    v_max_f32 v190, v190, v191
    v_max_f32 v206, v206, v207
    v_mul_f32 v190, s39, v190
    v_mul_f32 v206, s39, v206
    v_mov_b32 v191, v190
    v_mov_b32 v207, v206
    s_nop 0
    v_permlane32_swap_b32 v190, v191
    v_permlane32_swap_b32 v206, v207
    v_fma_f32 v64, v32, s38, v190
    v_fma_f32 v136, v48, s38, v206
    v_fma_f32 v74, v32, s39, v191
    v_fma_f32 v146, v48, s39, v207
    v_fma_f32 v65, v33, s38, v190
    v_fma_f32 v137, v49, s38, v206
    v_fma_f32 v75, v33, s39, v191
    v_fma_f32 v147, v49, s39, v207
    v_fma_f32 v66, v34, s38, v190
    v_fma_f32 v138, v50, s38, v206
    v_fma_f32 v76, v34, s39, v191
    v_fma_f32 v148, v50, s39, v207
    v_fma_f32 v67, v35, s38, v190
    v_fma_f32 v139, v51, s38, v206
    v_fma_f32 v77, v35, s39, v191
    v_fma_f32 v149, v51, s39, v207
    v_fma_f32 v68, v36, s38, v190
    v_fma_f32 v140, v52, s38, v206
    v_fma_f32 v78, v36, s39, v191
    v_fma_f32 v150, v52, s39, v207
    v_fma_f32 v69, v37, s38, v190
    v_fma_f32 v141, v53, s38, v206
    v_fma_f32 v79, v37, s39, v191
    v_fma_f32 v151, v53, s39, v207
    v_fma_f32 v70, v38, s38, v190
    v_fma_f32 v142, v54, s38, v206
    v_fma_f32 v80, v38, s39, v191
    v_fma_f32 v152, v54, s39, v207
    v_fma_f32 v71, v39, s38, v190
    v_fma_f32 v143, v55, s38, v206
    v_fma_f32 v81, v39, s39, v191
    v_fma_f32 v153, v55, s39, v207
    v_fma_f32 v72, v40, s38, v190
    v_fma_f32 v144, v56, s38, v206
    v_fma_f32 v82, v40, s39, v191
    v_fma_f32 v154, v56, s39, v207
    v_fma_f32 v73, v41, s38, v190
    v_fma_f32 v145, v57, s38, v206
    v_fma_f32 v83, v41, s39, v191
    v_fma_f32 v155, v57, s39, v207
    v_exp_f32 v64, v64
    v_exp_f32 v136, v136
    v_exp_f32 v74, v74
    v_exp_f32 v146, v146
    v_exp_f32 v65, v65
    v_exp_f32 v137, v137
    v_exp_f32 v75, v75
    v_exp_f32 v147, v147
    v_exp_f32 v66, v66
    v_exp_f32 v138, v138
    v_exp_f32 v76, v76
    v_exp_f32 v148, v148
    v_exp_f32 v67, v67
    v_exp_f32 v139, v139
    v_exp_f32 v77, v77
    v_exp_f32 v149, v149
    v_exp_f32 v68, v68
    v_exp_f32 v140, v140
    v_exp_f32 v78, v78
    v_exp_f32 v150, v150
    v_exp_f32 v69, v69
    v_exp_f32 v141, v141
    v_exp_f32 v79, v79
    v_exp_f32 v151, v151
    v_exp_f32 v70, v70
    v_exp_f32 v142, v142
    v_exp_f32 v80, v80
    v_exp_f32 v152, v152
    v_exp_f32 v71, v71
    v_exp_f32 v143, v143
    v_exp_f32 v81, v81
    v_exp_f32 v153, v153
    v_exp_f32 v72, v72
    v_exp_f32 v144, v144
    v_exp_f32 v82, v82
    v_exp_f32 v154, v154
    v_exp_f32 v73, v73
    v_exp_f32 v145, v145
    v_exp_f32 v83, v83
    v_exp_f32 v155, v155
    v_pk_add_f32 v[194:195], v[64:65], v[66:67]
    v_pk_add_f32 v[210:211], v[136:137], v[138:139]
    v_pk_add_f32 v[196:197], v[74:75], v[76:77]
    v_pk_add_f32 v[212:213], v[146:147], v[148:149]
    v_pk_add_f32 v[194:195], v[194:195], v[68:69]
    v_pk_add_f32 v[210:211], v[210:211], v[140:141]
    v_pk_add_f32 v[196:197], v[196:197], v[78:79]
    v_pk_add_f32 v[212:213], v[212:213], v[150:151]
    v_pk_add_f32 v[194:195], v[194:195], v[70:71]
    v_pk_add_f32 v[210:211], v[210:211], v[142:143]
    v_pk_add_f32 v[196:197], v[196:197], v[80:81]
    v_pk_add_f32 v[212:213], v[212:213], v[152:153]
    v_pk_add_f32 v[194:195], v[194:195], v[72:73]
    v_pk_add_f32 v[210:211], v[210:211], v[144:145]
    v_pk_add_f32 v[196:197], v[196:197], v[82:83]
    v_pk_add_f32 v[212:213], v[212:213], v[154:155]
    v_add_f32 v190, v194, v195
    v_add_f32 v206, v210, v211
    v_add_f32 v191, v196, v197
    v_add_f32 v207, v212, v213
    s_nop 0
    v_permlane32_swap_b32 v190, v191
    v_permlane32_swap_b32 v206, v207
    v_add_f32 v190, v190, v191
    v_add_f32 v206, v206, v207
    v_rcp_f32 v192, v190
    v_rcp_f32 v208, v206
    v_mov_b32 v193, v192
    v_mov_b32 v209, v208
    s_nop 0
    v_permlane32_swap_b32 v192, v193
    v_permlane32_swap_b32 v208, v209
    v_pk_mul_f32 v[64:65], v[64:65], v[192:193] op_sel_hi:[1,0]
    v_pk_mul_f32 v[136:137], v[136:137], v[208:209] op_sel_hi:[1,0]
    v_pk_mul_f32 v[74:75], v[74:75], v[192:193] op_sel:[0,1] op_sel_hi:[1,1]
    v_pk_mul_f32 v[146:147], v[146:147], v[208:209] op_sel:[0,1] op_sel_hi:[1,1]
    v_pk_mul_f32 v[66:67], v[66:67], v[192:193] op_sel_hi:[1,0]
    v_pk_mul_f32 v[138:139], v[138:139], v[208:209] op_sel_hi:[1,0]
    v_pk_mul_f32 v[76:77], v[76:77], v[192:193] op_sel:[0,1] op_sel_hi:[1,1]
    v_pk_mul_f32 v[148:149], v[148:149], v[208:209] op_sel:[0,1] op_sel_hi:[1,1]
    v_pk_mul_f32 v[68:69], v[68:69], v[192:193] op_sel_hi:[1,0]
    v_pk_mul_f32 v[140:141], v[140:141], v[208:209] op_sel_hi:[1,0]
    v_pk_mul_f32 v[78:79], v[78:79], v[192:193] op_sel:[0,1] op_sel_hi:[1,1]
    v_pk_mul_f32 v[150:151], v[150:151], v[208:209] op_sel:[0,1] op_sel_hi:[1,1]
    v_pk_mul_f32 v[70:71], v[70:71], v[192:193] op_sel_hi:[1,0]
    v_pk_mul_f32 v[142:143], v[142:143], v[208:209] op_sel_hi:[1,0]
    v_pk_mul_f32 v[80:81], v[80:81], v[192:193] op_sel:[0,1] op_sel_hi:[1,1]
    v_pk_mul_f32 v[152:153], v[152:153], v[208:209] op_sel:[0,1] op_sel_hi:[1,1]
    v_pk_mul_f32 v[72:73], v[72:73], v[192:193] op_sel_hi:[1,0]
    v_pk_mul_f32 v[144:145], v[144:145], v[208:209] op_sel_hi:[1,0]
    v_pk_mul_f32 v[82:83], v[82:83], v[192:193] op_sel:[0,1] op_sel_hi:[1,1]
    v_pk_mul_f32 v[154:155], v[154:155], v[208:209] op_sel:[0,1] op_sel_hi:[1,1]
    v_cvt_pk_bf16_f32 v84, v64, v65
    v_cvt_pk_bf16_f32 v156, v136, v137
    v_cvt_pk_bf16_f32 v89, v74, v75
    v_cvt_pk_bf16_f32 v161, v146, v147
    v_cvt_pk_bf16_f32 v85, v66, v67
    v_cvt_pk_bf16_f32 v157, v138, v139
    v_cvt_pk_bf16_f32 v90, v76, v77
    v_cvt_pk_bf16_f32 v162, v148, v149
    v_cvt_pk_bf16_f32 v86, v68, v69
    v_cvt_pk_bf16_f32 v158, v140, v141
    v_cvt_pk_bf16_f32 v91, v78, v79
    v_cvt_pk_bf16_f32 v163, v150, v151
    v_cvt_pk_bf16_f32 v87, v70, v71
    v_cvt_pk_bf16_f32 v159, v142, v143
    v_cvt_pk_bf16_f32 v92, v80, v81
    v_cvt_pk_bf16_f32 v94, v152, v153
    v_cvt_pk_bf16_f32 v88, v72, v73
    v_cvt_pk_bf16_f32 v160, v144, v145
    v_cvt_pk_bf16_f32 v93, v82, v83
    v_cvt_pk_bf16_f32 v95, v154, v155
    global_store_dwordx4 v201, v[84:87], s[34:35] sc1
    global_store_dwordx4 v201, v[88:91], s[34:35] offset:1024 sc1
    global_store_dwordx4 v201, v[156:159], s[34:35] offset:2048 sc1
    global_store_dwordx4 v201, v[160:163], s[34:35] offset:3072 sc1
    global_store_dwordx4 v202, v[92:95], s[34:35] offset:1024 sc1
    s_add_u32 s34, s34, 5120
    s_addc_u32 s35, s35, 0
    ds_read_b64_tr_b16 v[176:177], v188 offset:4800
    ds_read_b64_tr_b16 v[178:179], v188 offset:5120
    ds_read_b64_tr_b16 v[180:181], v189 offset:4800
    ds_read_b64_tr_b16 v[182:183], v188 offset:5600
    ds_read_b64_tr_b16 v[184:185], v188 offset:5920
    ds_read_b64_tr_b16 v[186:187], v189 offset:5600
    s_waitcnt lgkmcnt(0)
    v_cndmask_b32 v180, 0, v180, s[30:31]
    v_cndmask_b32 v181, 0, v181, s[30:31]
    v_cndmask_b32 v186, 0, v186, s[32:33]
    v_cndmask_b32 v187, 0, v187, s[32:33]
    v_mfma_f32_32x32x16_bf16 v[32:47], v[176:179], v[126:129], 0
    v_mfma_f32_32x32x16_bf16 v[48:63], v[182:185], v[130:133], 0
    v_mfma_f32_32x32x8_bf16 v[32:47], v[180:181], v[134:135], v[32:47]
    v_mfma_f32_32x32x8_bf16 v[48:63], v[186:187], v[134:135], v[48:63]
    v_cndmask_b32 v8, v8, v10, s[32:33]
    v_cndmask_b32 v24, v24, v26, s[32:33]
    v_cndmask_b32 v9, v9, v11, s[32:33]
    v_cndmask_b32 v25, v25, v27, s[32:33]
    v_max3_f32 v190, v0, v1, v2
    v_max3_f32 v206, v16, v17, v18
    v_max3_f32 v191, -v0, -v1, -v2
    v_max3_f32 v207, -v16, -v17, -v18
    v_max3_f32 v190, v190, v3, v4
    v_max3_f32 v206, v206, v19, v20
    v_max3_f32 v191, v191, -v3, -v4
    v_max3_f32 v207, v207, -v19, -v20
    v_max3_f32 v190, v190, v5, v6
    v_max3_f32 v206, v206, v21, v22
    v_max3_f32 v191, v191, -v5, -v6
    v_max3_f32 v207, v207, -v21, -v22
    v_max3_f32 v190, v190, v7, v8
    v_max3_f32 v206, v206, v23, v24
    v_max3_f32 v191, v191, -v7, -v8
    v_max3_f32 v207, v207, -v23, -v24
    v_max_f32 v190, v190, v9
    v_max_f32 v206, v206, v25
    v_max_f32 v191, v191, -v9
    v_max_f32 v207, v207, -v25
    s_nop 0
    v_permlane32_swap_b32 v190, v191
    v_permlane32_swap_b32 v206, v207
    v_max_f32 v190, v190, v191
    v_max_f32 v206, v206, v207
    v_mul_f32 v190, s39, v190
    v_mul_f32 v206, s39, v206
    v_mov_b32 v191, v190
    v_mov_b32 v207, v206
    s_nop 0
    v_permlane32_swap_b32 v190, v191
    v_permlane32_swap_b32 v206, v207
    v_fma_f32 v64, v0, s38, v190
    v_fma_f32 v136, v16, s38, v206
    v_fma_f32 v74, v0, s39, v191
    v_fma_f32 v146, v16, s39, v207
    v_fma_f32 v65, v1, s38, v190
    v_fma_f32 v137, v17, s38, v206
    v_fma_f32 v75, v1, s39, v191
    v_fma_f32 v147, v17, s39, v207
    v_fma_f32 v66, v2, s38, v190
    v_fma_f32 v138, v18, s38, v206
    v_fma_f32 v76, v2, s39, v191
    v_fma_f32 v148, v18, s39, v207
    v_fma_f32 v67, v3, s38, v190
    v_fma_f32 v139, v19, s38, v206
    v_fma_f32 v77, v3, s39, v191
    v_fma_f32 v149, v19, s39, v207
    v_fma_f32 v68, v4, s38, v190
    v_fma_f32 v140, v20, s38, v206
    v_fma_f32 v78, v4, s39, v191
    v_fma_f32 v150, v20, s39, v207
    v_fma_f32 v69, v5, s38, v190
    v_fma_f32 v141, v21, s38, v206
    v_fma_f32 v79, v5, s39, v191
    v_fma_f32 v151, v21, s39, v207
    v_fma_f32 v70, v6, s38, v190
    v_fma_f32 v142, v22, s38, v206
    v_fma_f32 v80, v6, s39, v191
    v_fma_f32 v152, v22, s39, v207
    v_fma_f32 v71, v7, s38, v190
    v_fma_f32 v143, v23, s38, v206
    v_fma_f32 v81, v7, s39, v191
    v_fma_f32 v153, v23, s39, v207
    v_fma_f32 v72, v8, s38, v190
    v_fma_f32 v144, v24, s38, v206
    v_fma_f32 v82, v8, s39, v191
    v_fma_f32 v154, v24, s39, v207
    v_fma_f32 v73, v9, s38, v190
    v_fma_f32 v145, v25, s38, v206
    v_fma_f32 v83, v9, s39, v191
    v_fma_f32 v155, v25, s39, v207
    v_exp_f32 v64, v64
    v_exp_f32 v136, v136
    v_exp_f32 v74, v74
    v_exp_f32 v146, v146
    v_exp_f32 v65, v65
    v_exp_f32 v137, v137
    v_exp_f32 v75, v75
    v_exp_f32 v147, v147
    v_exp_f32 v66, v66
    v_exp_f32 v138, v138
    v_exp_f32 v76, v76
    v_exp_f32 v148, v148
    v_exp_f32 v67, v67
    v_exp_f32 v139, v139
    v_exp_f32 v77, v77
    v_exp_f32 v149, v149
    v_exp_f32 v68, v68
    v_exp_f32 v140, v140
    v_exp_f32 v78, v78
    v_exp_f32 v150, v150
    v_exp_f32 v69, v69
    v_exp_f32 v141, v141
    v_exp_f32 v79, v79
    v_exp_f32 v151, v151
    v_exp_f32 v70, v70
    v_exp_f32 v142, v142
    v_exp_f32 v80, v80
    v_exp_f32 v152, v152
    v_exp_f32 v71, v71
    v_exp_f32 v143, v143
    v_exp_f32 v81, v81
    v_exp_f32 v153, v153
    v_exp_f32 v72, v72
    v_exp_f32 v144, v144
    v_exp_f32 v82, v82
    v_exp_f32 v154, v154
    v_exp_f32 v73, v73
    v_exp_f32 v145, v145
    v_exp_f32 v83, v83
    v_exp_f32 v155, v155
    v_pk_add_f32 v[194:195], v[64:65], v[66:67]
    v_pk_add_f32 v[210:211], v[136:137], v[138:139]
    v_pk_add_f32 v[196:197], v[74:75], v[76:77]
    v_pk_add_f32 v[212:213], v[146:147], v[148:149]
    v_pk_add_f32 v[194:195], v[194:195], v[68:69]
    v_pk_add_f32 v[210:211], v[210:211], v[140:141]
    v_pk_add_f32 v[196:197], v[196:197], v[78:79]
    v_pk_add_f32 v[212:213], v[212:213], v[150:151]
    v_pk_add_f32 v[194:195], v[194:195], v[70:71]
    v_pk_add_f32 v[210:211], v[210:211], v[142:143]
    v_pk_add_f32 v[196:197], v[196:197], v[80:81]
    v_pk_add_f32 v[212:213], v[212:213], v[152:153]
    v_pk_add_f32 v[194:195], v[194:195], v[72:73]
    v_pk_add_f32 v[210:211], v[210:211], v[144:145]
    v_pk_add_f32 v[196:197], v[196:197], v[82:83]
    v_pk_add_f32 v[212:213], v[212:213], v[154:155]
    v_add_f32 v190, v194, v195
    v_add_f32 v206, v210, v211
    v_add_f32 v191, v196, v197
    v_add_f32 v207, v212, v213
    s_nop 0
    v_permlane32_swap_b32 v190, v191
    v_permlane32_swap_b32 v206, v207
    v_add_f32 v190, v190, v191
    v_add_f32 v206, v206, v207
    v_rcp_f32 v192, v190
    v_rcp_f32 v208, v206
    v_mov_b32 v193, v192
    v_mov_b32 v209, v208
    s_nop 0
    v_permlane32_swap_b32 v192, v193
    v_permlane32_swap_b32 v208, v209
    v_pk_mul_f32 v[64:65], v[64:65], v[192:193] op_sel_hi:[1,0]
    v_pk_mul_f32 v[136:137], v[136:137], v[208:209] op_sel_hi:[1,0]
    v_pk_mul_f32 v[74:75], v[74:75], v[192:193] op_sel:[0,1] op_sel_hi:[1,1]
    v_pk_mul_f32 v[146:147], v[146:147], v[208:209] op_sel:[0,1] op_sel_hi:[1,1]
    v_pk_mul_f32 v[66:67], v[66:67], v[192:193] op_sel_hi:[1,0]
    v_pk_mul_f32 v[138:139], v[138:139], v[208:209] op_sel_hi:[1,0]
    v_pk_mul_f32 v[76:77], v[76:77], v[192:193] op_sel:[0,1] op_sel_hi:[1,1]
    v_pk_mul_f32 v[148:149], v[148:149], v[208:209] op_sel:[0,1] op_sel_hi:[1,1]
    v_pk_mul_f32 v[68:69], v[68:69], v[192:193] op_sel_hi:[1,0]
    v_pk_mul_f32 v[140:141], v[140:141], v[208:209] op_sel_hi:[1,0]
    v_pk_mul_f32 v[78:79], v[78:79], v[192:193] op_sel:[0,1] op_sel_hi:[1,1]
    v_pk_mul_f32 v[150:151], v[150:151], v[208:209] op_sel:[0,1] op_sel_hi:[1,1]
    v_pk_mul_f32 v[70:71], v[70:71], v[192:193] op_sel_hi:[1,0]
    v_pk_mul_f32 v[142:143], v[142:143], v[208:209] op_sel_hi:[1,0]
    v_pk_mul_f32 v[80:81], v[80:81], v[192:193] op_sel:[0,1] op_sel_hi:[1,1]
    v_pk_mul_f32 v[152:153], v[152:153], v[208:209] op_sel:[0,1] op_sel_hi:[1,1]
    v_pk_mul_f32 v[72:73], v[72:73], v[192:193] op_sel_hi:[1,0]
    v_pk_mul_f32 v[144:145], v[144:145], v[208:209] op_sel_hi:[1,0]
    v_pk_mul_f32 v[82:83], v[82:83], v[192:193] op_sel:[0,1] op_sel_hi:[1,1]
    v_pk_mul_f32 v[154:155], v[154:155], v[208:209] op_sel:[0,1] op_sel_hi:[1,1]
    v_cvt_pk_bf16_f32 v84, v64, v65
    v_cvt_pk_bf16_f32 v156, v136, v137
    v_cvt_pk_bf16_f32 v89, v74, v75
    v_cvt_pk_bf16_f32 v161, v146, v147
    v_cvt_pk_bf16_f32 v85, v66, v67
    v_cvt_pk_bf16_f32 v157, v138, v139
    v_cvt_pk_bf16_f32 v90, v76, v77
    v_cvt_pk_bf16_f32 v162, v148, v149
    v_cvt_pk_bf16_f32 v86, v68, v69
    v_cvt_pk_bf16_f32 v158, v140, v141
    v_cvt_pk_bf16_f32 v91, v78, v79
    v_cvt_pk_bf16_f32 v163, v150, v151
    v_cvt_pk_bf16_f32 v87, v70, v71
    v_cvt_pk_bf16_f32 v159, v142, v143
    v_cvt_pk_bf16_f32 v92, v80, v81
    v_cvt_pk_bf16_f32 v94, v152, v153
    v_cvt_pk_bf16_f32 v88, v72, v73
    v_cvt_pk_bf16_f32 v160, v144, v145
    v_cvt_pk_bf16_f32 v93, v82, v83
    v_cvt_pk_bf16_f32 v95, v154, v155
    global_store_dwordx4 v201, v[84:87], s[34:35] sc1
    global_store_dwordx4 v201, v[88:91], s[34:35] offset:1024 sc1
    global_store_dwordx4 v201, v[156:159], s[34:35] offset:2048 sc1
    global_store_dwordx4 v201, v[160:163], s[34:35] offset:3072 sc1
    global_store_dwordx4 v202, v[92:95], s[34:35] offset:1024 sc1
    s_add_u32 s34, s34, 5120
    s_addc_u32 s35, s35, 0
    v_cndmask_b32 v40, v40, v42, s[32:33]
    v_cndmask_b32 v56, v56, v58, s[32:33]
    v_cndmask_b32 v41, v41, v43, s[32:33]
    v_cndmask_b32 v57, v57, v59, s[32:33]
    v_max3_f32 v190, v32, v33, v34
    v_max3_f32 v206, v48, v49, v50
    v_max3_f32 v191, -v32, -v33, -v34
    v_max3_f32 v207, -v48, -v49, -v50
    v_max3_f32 v190, v190, v35, v36
    v_max3_f32 v206, v206, v51, v52
    v_max3_f32 v191, v191, -v35, -v36
    v_max3_f32 v207, v207, -v51, -v52
    v_max3_f32 v190, v190, v37, v38
    v_max3_f32 v206, v206, v53, v54
    v_max3_f32 v191, v191, -v37, -v38
    v_max3_f32 v207, v207, -v53, -v54
    v_max3_f32 v190, v190, v39, v40
    v_max3_f32 v206, v206, v55, v56
    v_max3_f32 v191, v191, -v39, -v40
    v_max3_f32 v207, v207, -v55, -v56
    v_max_f32 v190, v190, v41
    v_max_f32 v206, v206, v57
    v_max_f32 v191, v191, -v41
    v_max_f32 v207, v207, -v57
    s_nop 0
    v_permlane32_swap_b32 v190, v191
    v_permlane32_swap_b32 v206, v207
    v_max_f32 v190, v190, v191
    v_max_f32 v206, v206, v207
    v_mul_f32 v190, s39, v190
    v_mul_f32 v206, s39, v206
    v_mov_b32 v191, v190
    v_mov_b32 v207, v206
    s_nop 0
    v_permlane32_swap_b32 v190, v191
    v_permlane32_swap_b32 v206, v207
    v_fma_f32 v64, v32, s38, v190
    v_fma_f32 v136, v48, s38, v206
    v_fma_f32 v74, v32, s39, v191
    v_fma_f32 v146, v48, s39, v207
    v_fma_f32 v65, v33, s38, v190
    v_fma_f32 v137, v49, s38, v206
    v_fma_f32 v75, v33, s39, v191
    v_fma_f32 v147, v49, s39, v207
    v_fma_f32 v66, v34, s38, v190
    v_fma_f32 v138, v50, s38, v206
    v_fma_f32 v76, v34, s39, v191
    v_fma_f32 v148, v50, s39, v207
    v_fma_f32 v67, v35, s38, v190
    v_fma_f32 v139, v51, s38, v206
    v_fma_f32 v77, v35, s39, v191
    v_fma_f32 v149, v51, s39, v207
    v_fma_f32 v68, v36, s38, v190
    v_fma_f32 v140, v52, s38, v206
    v_fma_f32 v78, v36, s39, v191
    v_fma_f32 v150, v52, s39, v207
    v_fma_f32 v69, v37, s38, v190
    v_fma_f32 v141, v53, s38, v206
    v_fma_f32 v79, v37, s39, v191
    v_fma_f32 v151, v53, s39, v207
    v_fma_f32 v70, v38, s38, v190
    v_fma_f32 v142, v54, s38, v206
    v_fma_f32 v80, v38, s39, v191
    v_fma_f32 v152, v54, s39, v207
    v_fma_f32 v71, v39, s38, v190
    v_fma_f32 v143, v55, s38, v206
    v_fma_f32 v81, v39, s39, v191
    v_fma_f32 v153, v55, s39, v207
    v_fma_f32 v72, v40, s38, v190
    v_fma_f32 v144, v56, s38, v206
    v_fma_f32 v82, v40, s39, v191
    v_fma_f32 v154, v56, s39, v207
    v_fma_f32 v73, v41, s38, v190
    v_fma_f32 v145, v57, s38, v206
    v_fma_f32 v83, v41, s39, v191
    v_fma_f32 v155, v57, s39, v207
    v_exp_f32 v64, v64
    v_exp_f32 v136, v136
    v_exp_f32 v74, v74
    v_exp_f32 v146, v146
    v_exp_f32 v65, v65
    v_exp_f32 v137, v137
    v_exp_f32 v75, v75
    v_exp_f32 v147, v147
    v_exp_f32 v66, v66
    v_exp_f32 v138, v138
    v_exp_f32 v76, v76
    v_exp_f32 v148, v148
    v_exp_f32 v67, v67
    v_exp_f32 v139, v139
    v_exp_f32 v77, v77
    v_exp_f32 v149, v149
    v_exp_f32 v68, v68
    v_exp_f32 v140, v140
    v_exp_f32 v78, v78
    v_exp_f32 v150, v150
    v_exp_f32 v69, v69
    v_exp_f32 v141, v141
    v_exp_f32 v79, v79
    v_exp_f32 v151, v151
    v_exp_f32 v70, v70
    v_exp_f32 v142, v142
    v_exp_f32 v80, v80
    v_exp_f32 v152, v152
    v_exp_f32 v71, v71
    v_exp_f32 v143, v143
    v_exp_f32 v81, v81
    v_exp_f32 v153, v153
    v_exp_f32 v72, v72
    v_exp_f32 v144, v144
    v_exp_f32 v82, v82
    v_exp_f32 v154, v154
    v_exp_f32 v73, v73
    v_exp_f32 v145, v145
    v_exp_f32 v83, v83
    v_exp_f32 v155, v155
    v_pk_add_f32 v[194:195], v[64:65], v[66:67]
    v_pk_add_f32 v[210:211], v[136:137], v[138:139]
    v_pk_add_f32 v[196:197], v[74:75], v[76:77]
    v_pk_add_f32 v[212:213], v[146:147], v[148:149]
    v_pk_add_f32 v[194:195], v[194:195], v[68:69]
    v_pk_add_f32 v[210:211], v[210:211], v[140:141]
    v_pk_add_f32 v[196:197], v[196:197], v[78:79]
    v_pk_add_f32 v[212:213], v[212:213], v[150:151]
    v_pk_add_f32 v[194:195], v[194:195], v[70:71]
    v_pk_add_f32 v[210:211], v[210:211], v[142:143]
    v_pk_add_f32 v[196:197], v[196:197], v[80:81]
    v_pk_add_f32 v[212:213], v[212:213], v[152:153]
    v_pk_add_f32 v[194:195], v[194:195], v[72:73]
    v_pk_add_f32 v[210:211], v[210:211], v[144:145]
    v_pk_add_f32 v[196:197], v[196:197], v[82:83]
    v_pk_add_f32 v[212:213], v[212:213], v[154:155]
    v_add_f32 v190, v194, v195
    v_add_f32 v206, v210, v211
    v_add_f32 v191, v196, v197
    v_add_f32 v207, v212, v213
    s_nop 0
    v_permlane32_swap_b32 v190, v191
    v_permlane32_swap_b32 v206, v207
    v_add_f32 v190, v190, v191
    v_add_f32 v206, v206, v207
    v_rcp_f32 v192, v190
    v_rcp_f32 v208, v206
    v_mov_b32 v193, v192
    v_mov_b32 v209, v208
    s_nop 0
    v_permlane32_swap_b32 v192, v193
    v_permlane32_swap_b32 v208, v209
    v_pk_mul_f32 v[64:65], v[64:65], v[192:193] op_sel_hi:[1,0]
    v_pk_mul_f32 v[136:137], v[136:137], v[208:209] op_sel_hi:[1,0]
    v_pk_mul_f32 v[74:75], v[74:75], v[192:193] op_sel:[0,1] op_sel_hi:[1,1]
    v_pk_mul_f32 v[146:147], v[146:147], v[208:209] op_sel:[0,1] op_sel_hi:[1,1]
    v_pk_mul_f32 v[66:67], v[66:67], v[192:193] op_sel_hi:[1,0]
    v_pk_mul_f32 v[138:139], v[138:139], v[208:209] op_sel_hi:[1,0]
    v_pk_mul_f32 v[76:77], v[76:77], v[192:193] op_sel:[0,1] op_sel_hi:[1,1]
    v_pk_mul_f32 v[148:149], v[148:149], v[208:209] op_sel:[0,1] op_sel_hi:[1,1]
    v_pk_mul_f32 v[68:69], v[68:69], v[192:193] op_sel_hi:[1,0]
    v_pk_mul_f32 v[140:141], v[140:141], v[208:209] op_sel_hi:[1,0]
    v_pk_mul_f32 v[78:79], v[78:79], v[192:193] op_sel:[0,1] op_sel_hi:[1,1]
    v_pk_mul_f32 v[150:151], v[150:151], v[208:209] op_sel:[0,1] op_sel_hi:[1,1]
    v_pk_mul_f32 v[70:71], v[70:71], v[192:193] op_sel_hi:[1,0]
    v_pk_mul_f32 v[142:143], v[142:143], v[208:209] op_sel_hi:[1,0]
    v_pk_mul_f32 v[80:81], v[80:81], v[192:193] op_sel:[0,1] op_sel_hi:[1,1]
    v_pk_mul_f32 v[152:153], v[152:153], v[208:209] op_sel:[0,1] op_sel_hi:[1,1]
    v_pk_mul_f32 v[72:73], v[72:73], v[192:193] op_sel_hi:[1,0]
    v_pk_mul_f32 v[144:145], v[144:145], v[208:209] op_sel_hi:[1,0]
    v_pk_mul_f32 v[82:83], v[82:83], v[192:193] op_sel:[0,1] op_sel_hi:[1,1]
    v_pk_mul_f32 v[154:155], v[154:155], v[208:209] op_sel:[0,1] op_sel_hi:[1,1]
    v_cvt_pk_bf16_f32 v84, v64, v65
    v_cvt_pk_bf16_f32 v156, v136, v137
    v_cvt_pk_bf16_f32 v89, v74, v75
    v_cvt_pk_bf16_f32 v161, v146, v147
    v_cvt_pk_bf16_f32 v85, v66, v67
    v_cvt_pk_bf16_f32 v157, v138, v139
    v_cvt_pk_bf16_f32 v90, v76, v77
    v_cvt_pk_bf16_f32 v162, v148, v149
    v_cvt_pk_bf16_f32 v86, v68, v69
    v_cvt_pk_bf16_f32 v158, v140, v141
    v_cvt_pk_bf16_f32 v91, v78, v79
    v_cvt_pk_bf16_f32 v163, v150, v151
    v_cvt_pk_bf16_f32 v87, v70, v71
    v_cvt_pk_bf16_f32 v159, v142, v143
    v_cvt_pk_bf16_f32 v92, v80, v81
    v_cvt_pk_bf16_f32 v94, v152, v153
    v_cvt_pk_bf16_f32 v88, v72, v73
    v_cvt_pk_bf16_f32 v160, v144, v145
    v_cvt_pk_bf16_f32 v93, v82, v83
    v_cvt_pk_bf16_f32 v95, v154, v155
    global_store_dwordx4 v201, v[84:87], s[34:35] sc1
    global_store_dwordx4 v201, v[88:91], s[34:35] offset:1024 sc1
    global_store_dwordx4 v201, v[156:159], s[34:35] offset:2048 sc1
    global_store_dwordx4 v201, v[160:163], s[34:35] offset:3072 sc1
    global_store_dwordx4 v202, v[92:95], s[34:35] offset:1024 sc1
    s_branch P1_fin
P1_epiBkv:
    v_bfe_u32 v190, v200, 4, 1
    v_lshlrev_b32 v190, 2, v190
    v_and_b32 v191, 3, v200
    v_add_u32 v190, v190, v191
    v_min_u32 v190, 4, v190
    v_lshlrev_b32 v190, 3, v190
    v_bfe_u32 v191, v200, 2, 2
    v_mul_u32_u24 v191, 40, v191
    v_add_u32 v190, v190, v191
    v_add_u32 v189, 148096, v190
    v_lshrrev_b32 v191, 5, v200
    v_mul_u32_u24 v191, 160, v191
    v_add_u32 v190, v190, v191
    v_add_u32 v188, 147456, v190
    ds_read_b64_tr_b16 v[164:165], v188 offset:0
    ds_read_b64_tr_b16 v[166:167], v188 offset:320
    ds_read_b64_tr_b16 v[168:169], v189 offset:0
    ds_read_b64_tr_b16 v[170:171], v188 offset:800
    ds_read_b64_tr_b16 v[172:173], v188 offset:1120
    ds_read_b64_tr_b16 v[174:175], v189 offset:800
    v_cvt_pk_bf16_f32 v96, v0, v1
    v_cvt_pk_bf16_f32 v97, v2, v3
    v_cvt_pk_bf16_f32 v98, v4, v5
    v_cvt_pk_bf16_f32 v99, v6, v7
    v_cvt_pk_bf16_f32 v100, v12, v13
    v_cvt_pk_bf16_f32 v101, v14, v15
    v_cvt_pk_bf16_f32 v102, v16, v17
    v_cvt_pk_bf16_f32 v103, v18, v19
    v_cvt_pk_bf16_f32 v104, v8, v9
    v_cvt_pk_bf16_f32 v105, v10, v11
    v_cvt_pk_bf16_f32 v106, v20, v21
    v_cvt_pk_bf16_f32 v107, v22, v23
    v_cvt_pk_bf16_f32 v108, v24, v25
    v_cvt_pk_bf16_f32 v109, v26, v27
    v_cvt_pk_bf16_f32 v110, v32, v33
    v_cvt_pk_bf16_f32 v111, v34, v35
    v_cvt_pk_bf16_f32 v112, v36, v37
    v_cvt_pk_bf16_f32 v113, v38, v39
    v_cvt_pk_bf16_f32 v114, v28, v29
    v_cvt_pk_bf16_f32 v115, v30, v31
    v_cvt_pk_bf16_f32 v116, v40, v41
    v_cvt_pk_bf16_f32 v117, v42, v43
    v_cvt_pk_bf16_f32 v118, v44, v45
    v_cvt_pk_bf16_f32 v119, v46, v47
    v_cvt_pk_bf16_f32 v120, v52, v53
    v_cvt_pk_bf16_f32 v121, v54, v55
    v_cvt_pk_bf16_f32 v122, v56, v57
    v_cvt_pk_bf16_f32 v123, v58, v59
    v_cvt_pk_bf16_f32 v124, v48, v49
    v_cvt_pk_bf16_f32 v125, v50, v51
    v_cvt_pk_bf16_f32 v126, v60, v61
    v_cvt_pk_bf16_f32 v127, v62, v63
    v_cvt_pk_bf16_f32 v128, v64, v65
    v_cvt_pk_bf16_f32 v129, v66, v67
    v_cvt_pk_bf16_f32 v130, v72, v73
    v_cvt_pk_bf16_f32 v131, v74, v75
    v_cvt_pk_bf16_f32 v132, v76, v77
    v_cvt_pk_bf16_f32 v133, v78, v79
    v_cvt_pk_bf16_f32 v134, v68, v69
    v_cvt_pk_bf16_f32 v135, v70, v71
    s_mov_b32 s38, 1069066811
    s_mov_b32 s39, 3216550459
    s_barrier
    v_and_b32 v202, 31, v200
    s_lshl_b32 s14, s10, 5
    v_add_u32 v202, s14, v202
    v_lshrrev_b32 v205, 5, v200
    v_mul_u32_u24 v203, 80, v202
    v_lshl_add_u32 v203, v205, 3, v203
    v_mul_u32_u24 v204, 48, v202
    v_add_u32 v204, 40960, v204
    v_lshl_add_u32 v214, v205, 3, v204
    v_mul_u32_u24 v215, 6144, v205
    v_add_u32 v215, v215, v204
    v_mov_b32 v216, 0x3f80
    v_mov_b32 v217, 0
    s_waitcnt lgkmcnt(0)
    v_cndmask_b32 v168, 0, v168, s[30:31]
    v_cndmask_b32 v169, 0, v169, s[30:31]
    v_cndmask_b32 v174, 0, v174, s[32:33]
    v_cndmask_b32 v175, 0, v175, s[32:33]
    v_mfma_f32_32x32x16_bf16 v[0:15], v[164:167], v[96:99], 0
    v_mfma_f32_32x32x16_bf16 v[16:31], v[170:173], v[100:103], 0
    v_mfma_f32_32x32x8_bf16 v[0:15], v[168:169], v[104:105], v[0:15]
    v_mfma_f32_32x32x8_bf16 v[16:31], v[174:175], v[104:105], v[16:31]
    ds_write_b64 v214, v[116:117] offset:0
    ds_write_b64 v214, v[118:119] offset:16
    ds_write_b64 v204, v[216:217] offset:40
    ds_write_b64 v214, v[120:121] offset:6144
    ds_write_b64 v214, v[122:123] offset:6160
    ds_write_b64 v204, v[216:217] offset:6184
    ds_write_b64 v215, v[124:125] offset:32
    ds_write_b64 v214, v[126:127] offset:12288
    ds_write_b64 v214, v[128:129] offset:12304
    ds_write_b64 v204, v[216:217] offset:12328
    ds_write_b64 v214, v[130:131] offset:18432
    ds_write_b64 v214, v[132:133] offset:18448
    ds_write_b64 v204, v[216:217] offset:18472
    ds_write_b64 v215, v[134:135] offset:12320
    ds_read_b64_tr_b16 v[176:177], v188 offset:1600
    ds_read_b64_tr_b16 v[178:179], v188 offset:1920
    ds_read_b64_tr_b16 v[180:181], v189 offset:1600
    ds_read_b64_tr_b16 v[182:183], v188 offset:2400
    ds_read_b64_tr_b16 v[184:185], v188 offset:2720
    ds_read_b64_tr_b16 v[186:187], v189 offset:2400
    s_waitcnt lgkmcnt(0)
    v_cndmask_b32 v180, 0, v180, s[30:31]
    v_cndmask_b32 v181, 0, v181, s[30:31]
    v_cndmask_b32 v186, 0, v186, s[32:33]
    v_cndmask_b32 v187, 0, v187, s[32:33]
    v_mfma_f32_32x32x16_bf16 v[32:47], v[176:179], v[106:109], 0
    v_mfma_f32_32x32x16_bf16 v[48:63], v[182:185], v[110:113], 0
    v_mfma_f32_32x32x8_bf16 v[32:47], v[180:181], v[114:115], v[32:47]
    v_mfma_f32_32x32x8_bf16 v[48:63], v[186:187], v[114:115], v[48:63]
    v_cndmask_b32 v8, v8, v10, s[32:33]
    v_cndmask_b32 v24, v24, v26, s[32:33]
    v_cndmask_b32 v9, v9, v11, s[32:33]
    v_cndmask_b32 v25, v25, v27, s[32:33]
    v_max3_f32 v190, v0, v1, v2
    v_max3_f32 v206, v16, v17, v18
    v_max3_f32 v191, -v0, -v1, -v2
    v_max3_f32 v207, -v16, -v17, -v18
    v_max3_f32 v190, v190, v3, v4
    v_max3_f32 v206, v206, v19, v20
    v_max3_f32 v191, v191, -v3, -v4
    v_max3_f32 v207, v207, -v19, -v20
    v_max3_f32 v190, v190, v5, v6
    v_max3_f32 v206, v206, v21, v22
    v_max3_f32 v191, v191, -v5, -v6
    v_max3_f32 v207, v207, -v21, -v22
    v_max3_f32 v190, v190, v7, v8
    v_max3_f32 v206, v206, v23, v24
    v_max3_f32 v191, v191, -v7, -v8
    v_max3_f32 v207, v207, -v23, -v24
    v_max_f32 v190, v190, v9
    v_max_f32 v206, v206, v25
    v_max_f32 v191, v191, -v9
    v_max_f32 v207, v207, -v25
    s_nop 0
    v_permlane32_swap_b32 v190, v191
    v_permlane32_swap_b32 v206, v207
    v_max_f32 v190, v190, v191
    v_max_f32 v206, v206, v207
    v_mul_f32 v190, s39, v190
    v_mul_f32 v206, s39, v206
    v_mov_b32 v191, v190
    v_mov_b32 v207, v206
    s_nop 0
    v_permlane32_swap_b32 v190, v191
    v_permlane32_swap_b32 v206, v207
    v_fma_f32 v64, v0, s38, v190
    v_fma_f32 v136, v16, s38, v206
    v_fma_f32 v74, v0, s39, v191
    v_fma_f32 v146, v16, s39, v207
    v_fma_f32 v65, v1, s38, v190
    v_fma_f32 v137, v17, s38, v206
    v_fma_f32 v75, v1, s39, v191
    v_fma_f32 v147, v17, s39, v207
    v_fma_f32 v66, v2, s38, v190
    v_fma_f32 v138, v18, s38, v206
    v_fma_f32 v76, v2, s39, v191
    v_fma_f32 v148, v18, s39, v207
    v_fma_f32 v67, v3, s38, v190
    v_fma_f32 v139, v19, s38, v206
    v_fma_f32 v77, v3, s39, v191
    v_fma_f32 v149, v19, s39, v207
    v_fma_f32 v68, v4, s38, v190
    v_fma_f32 v140, v20, s38, v206
    v_fma_f32 v78, v4, s39, v191
    v_fma_f32 v150, v20, s39, v207
    v_fma_f32 v69, v5, s38, v190
    v_fma_f32 v141, v21, s38, v206
    v_fma_f32 v79, v5, s39, v191
    v_fma_f32 v151, v21, s39, v207
    v_fma_f32 v70, v6, s38, v190
    v_fma_f32 v142, v22, s38, v206
    v_fma_f32 v80, v6, s39, v191
    v_fma_f32 v152, v22, s39, v207
    v_fma_f32 v71, v7, s38, v190
    v_fma_f32 v143, v23, s38, v206
    v_fma_f32 v81, v7, s39, v191
    v_fma_f32 v153, v23, s39, v207
    v_fma_f32 v72, v8, s38, v190
    v_fma_f32 v144, v24, s38, v206
    v_fma_f32 v82, v8, s39, v191
    v_fma_f32 v154, v24, s39, v207
    v_fma_f32 v73, v9, s38, v190
    v_fma_f32 v145, v25, s38, v206
    v_fma_f32 v83, v9, s39, v191
    v_fma_f32 v155, v25, s39, v207
    v_exp_f32 v64, v64
    v_exp_f32 v136, v136
    v_exp_f32 v74, v74
    v_exp_f32 v146, v146
    v_exp_f32 v65, v65
    v_exp_f32 v137, v137
    v_exp_f32 v75, v75
    v_exp_f32 v147, v147
    v_exp_f32 v66, v66
    v_exp_f32 v138, v138
    v_exp_f32 v76, v76
    v_exp_f32 v148, v148
    v_exp_f32 v67, v67
    v_exp_f32 v139, v139
    v_exp_f32 v77, v77
    v_exp_f32 v149, v149
    v_exp_f32 v68, v68
    v_exp_f32 v140, v140
    v_exp_f32 v78, v78
    v_exp_f32 v150, v150
    v_exp_f32 v69, v69
    v_exp_f32 v141, v141
    v_exp_f32 v79, v79
    v_exp_f32 v151, v151
    v_exp_f32 v70, v70
    v_exp_f32 v142, v142
    v_exp_f32 v80, v80
    v_exp_f32 v152, v152
    v_exp_f32 v71, v71
    v_exp_f32 v143, v143
    v_exp_f32 v81, v81
    v_exp_f32 v153, v153
    v_exp_f32 v72, v72
    v_exp_f32 v144, v144
    v_exp_f32 v82, v82
    v_exp_f32 v154, v154
    v_exp_f32 v73, v73
    v_exp_f32 v145, v145
    v_exp_f32 v83, v83
    v_exp_f32 v155, v155
    v_pk_add_f32 v[194:195], v[64:65], v[66:67]
    v_pk_add_f32 v[210:211], v[136:137], v[138:139]
    v_pk_add_f32 v[196:197], v[74:75], v[76:77]
    v_pk_add_f32 v[212:213], v[146:147], v[148:149]
    v_pk_add_f32 v[194:195], v[194:195], v[68:69]
    v_pk_add_f32 v[210:211], v[210:211], v[140:141]
    v_pk_add_f32 v[196:197], v[196:197], v[78:79]
    v_pk_add_f32 v[212:213], v[212:213], v[150:151]
    v_pk_add_f32 v[194:195], v[194:195], v[70:71]
    v_pk_add_f32 v[210:211], v[210:211], v[142:143]
    v_pk_add_f32 v[196:197], v[196:197], v[80:81]
    v_pk_add_f32 v[212:213], v[212:213], v[152:153]
    v_pk_add_f32 v[194:195], v[194:195], v[72:73]
    v_pk_add_f32 v[210:211], v[210:211], v[144:145]
    v_pk_add_f32 v[196:197], v[196:197], v[82:83]
    v_pk_add_f32 v[212:213], v[212:213], v[154:155]
    v_add_f32 v190, v194, v195
    v_add_f32 v206, v210, v211
    v_add_f32 v191, v196, v197
    v_add_f32 v207, v212, v213
    s_nop 0
    v_permlane32_swap_b32 v190, v191
    v_permlane32_swap_b32 v206, v207
    v_add_f32 v190, v190, v191
    v_add_f32 v206, v206, v207
    v_rcp_f32 v192, v190
    v_rcp_f32 v208, v206
    v_mov_b32 v193, v192
    v_mov_b32 v209, v208
    s_nop 0
    v_permlane32_swap_b32 v192, v193
    v_permlane32_swap_b32 v208, v209
    v_pk_mul_f32 v[64:65], v[64:65], v[192:193] op_sel_hi:[1,0]
    v_pk_mul_f32 v[136:137], v[136:137], v[208:209] op_sel_hi:[1,0]
    v_pk_mul_f32 v[74:75], v[74:75], v[192:193] op_sel:[0,1] op_sel_hi:[1,1]
    v_pk_mul_f32 v[146:147], v[146:147], v[208:209] op_sel:[0,1] op_sel_hi:[1,1]
    v_pk_mul_f32 v[66:67], v[66:67], v[192:193] op_sel_hi:[1,0]
    v_pk_mul_f32 v[138:139], v[138:139], v[208:209] op_sel_hi:[1,0]
    v_pk_mul_f32 v[76:77], v[76:77], v[192:193] op_sel:[0,1] op_sel_hi:[1,1]
    v_pk_mul_f32 v[148:149], v[148:149], v[208:209] op_sel:[0,1] op_sel_hi:[1,1]
    v_pk_mul_f32 v[68:69], v[68:69], v[192:193] op_sel_hi:[1,0]
    v_pk_mul_f32 v[140:141], v[140:141], v[208:209] op_sel_hi:[1,0]
    v_pk_mul_f32 v[78:79], v[78:79], v[192:193] op_sel:[0,1] op_sel_hi:[1,1]
    v_pk_mul_f32 v[150:151], v[150:151], v[208:209] op_sel:[0,1] op_sel_hi:[1,1]
    v_pk_mul_f32 v[70:71], v[70:71], v[192:193] op_sel_hi:[1,0]
    v_pk_mul_f32 v[142:143], v[142:143], v[208:209] op_sel_hi:[1,0]
    v_pk_mul_f32 v[80:81], v[80:81], v[192:193] op_sel:[0,1] op_sel_hi:[1,1]
    v_pk_mul_f32 v[152:153], v[152:153], v[208:209] op_sel:[0,1] op_sel_hi:[1,1]
    v_pk_mul_f32 v[72:73], v[72:73], v[192:193] op_sel_hi:[1,0]
    v_pk_mul_f32 v[144:145], v[144:145], v[208:209] op_sel_hi:[1,0]
    v_pk_mul_f32 v[82:83], v[82:83], v[192:193] op_sel:[0,1] op_sel_hi:[1,1]
    v_pk_mul_f32 v[154:155], v[154:155], v[208:209] op_sel:[0,1] op_sel_hi:[1,1]
    v_cvt_pk_bf16_f32 v84, v64, v65
    v_cvt_pk_bf16_f32 v156, v136, v137
    v_cvt_pk_bf16_f32 v89, v74, v75
    v_cvt_pk_bf16_f32 v161, v146, v147
    v_cvt_pk_bf16_f32 v85, v66, v67
    v_cvt_pk_bf16_f32 v157, v138, v139
    v_cvt_pk_bf16_f32 v90, v76, v77
    v_cvt_pk_bf16_f32 v162, v148, v149
    v_cvt_pk_bf16_f32 v86, v68, v69
    v_cvt_pk_bf16_f32 v158, v140, v141
    v_cvt_pk_bf16_f32 v91, v78, v79
    v_cvt_pk_bf16_f32 v163, v150, v151
    v_cvt_pk_bf16_f32 v87, v70, v71
    v_cvt_pk_bf16_f32 v159, v142, v143
    v_cvt_pk_bf16_f32 v92, v80, v81
    v_cvt_pk_bf16_f32 v94, v152, v153
    v_cvt_pk_bf16_f32 v88, v72, v73
    v_cvt_pk_bf16_f32 v160, v144, v145
    v_cvt_pk_bf16_f32 v93, v82, v83
    v_cvt_pk_bf16_f32 v95, v154, v155
    ds_write_b64 v203, v[84:85] offset:0
    ds_write_b64 v203, v[86:87] offset:16
    ds_write_b64 v203, v[88:89] offset:32
    ds_write_b64 v203, v[90:91] offset:48
    ds_write_b64 v203, v[92:93] offset:64
    ds_write_b64 v203, v[156:157] offset:10240
    ds_write_b64 v203, v[158:159] offset:10256
    ds_write_b64 v203, v[160:161] offset:10272
    ds_write_b64 v203, v[162:163] offset:10288
    ds_write_b64 v203, v[94:95] offset:10304
    v_cndmask_b32 v40, v40, v42, s[32:33]
    v_cndmask_b32 v56, v56, v58, s[32:33]
    v_cndmask_b32 v41, v41, v43, s[32:33]
    v_cndmask_b32 v57, v57, v59, s[32:33]
    v_max3_f32 v190, v32, v33, v34
    v_max3_f32 v206, v48, v49, v50
    v_max3_f32 v191, -v32, -v33, -v34
    v_max3_f32 v207, -v48, -v49, -v50
    v_max3_f32 v190, v190, v35, v36
    v_max3_f32 v206, v206, v51, v52
    v_max3_f32 v191, v191, -v35, -v36
    v_max3_f32 v207, v207, -v51, -v52
    v_max3_f32 v190, v190, v37, v38
    v_max3_f32 v206, v206, v53, v54
    v_max3_f32 v191, v191, -v37, -v38
    v_max3_f32 v207, v207, -v53, -v54
    v_max3_f32 v190, v190, v39, v40
    v_max3_f32 v206, v206, v55, v56
    v_max3_f32 v191, v191, -v39, -v40
    v_max3_f32 v207, v207, -v55, -v56
    v_max_f32 v190, v190, v41
    v_max_f32 v206, v206, v57
    v_max_f32 v191, v191, -v41
    v_max_f32 v207, v207, -v57
    s_nop 0
    v_permlane32_swap_b32 v190, v191
    v_permlane32_swap_b32 v206, v207
    v_max_f32 v190, v190, v191
    v_max_f32 v206, v206, v207
    v_mul_f32 v190, s39, v190
    v_mul_f32 v206, s39, v206
    v_mov_b32 v191, v190
    v_mov_b32 v207, v206
    s_nop 0
    v_permlane32_swap_b32 v190, v191
    v_permlane32_swap_b32 v206, v207
    v_fma_f32 v64, v32, s38, v190
    v_fma_f32 v136, v48, s38, v206
    v_fma_f32 v74, v32, s39, v191
    v_fma_f32 v146, v48, s39, v207
    v_fma_f32 v65, v33, s38, v190
    v_fma_f32 v137, v49, s38, v206
    v_fma_f32 v75, v33, s39, v191
    v_fma_f32 v147, v49, s39, v207
    v_fma_f32 v66, v34, s38, v190
    v_fma_f32 v138, v50, s38, v206
    v_fma_f32 v76, v34, s39, v191
    v_fma_f32 v148, v50, s39, v207
    v_fma_f32 v67, v35, s38, v190
    v_fma_f32 v139, v51, s38, v206
    v_fma_f32 v77, v35, s39, v191
    v_fma_f32 v149, v51, s39, v207
    v_fma_f32 v68, v36, s38, v190
    v_fma_f32 v140, v52, s38, v206
    v_fma_f32 v78, v36, s39, v191
    v_fma_f32 v150, v52, s39, v207
    v_fma_f32 v69, v37, s38, v190
    v_fma_f32 v141, v53, s38, v206
    v_fma_f32 v79, v37, s39, v191
    v_fma_f32 v151, v53, s39, v207
    v_fma_f32 v70, v38, s38, v190
    v_fma_f32 v142, v54, s38, v206
    v_fma_f32 v80, v38, s39, v191
    v_fma_f32 v152, v54, s39, v207
    v_fma_f32 v71, v39, s38, v190
    v_fma_f32 v143, v55, s38, v206
    v_fma_f32 v81, v39, s39, v191
    v_fma_f32 v153, v55, s39, v207
    v_fma_f32 v72, v40, s38, v190
    v_fma_f32 v144, v56, s38, v206
    v_fma_f32 v82, v40, s39, v191
    v_fma_f32 v154, v56, s39, v207
    v_fma_f32 v73, v41, s38, v190
    v_fma_f32 v145, v57, s38, v206
    v_fma_f32 v83, v41, s39, v191
    v_fma_f32 v155, v57, s39, v207
    v_exp_f32 v64, v64
    v_exp_f32 v136, v136
    v_exp_f32 v74, v74
    v_exp_f32 v146, v146
    v_exp_f32 v65, v65
    v_exp_f32 v137, v137
    v_exp_f32 v75, v75
    v_exp_f32 v147, v147
    v_exp_f32 v66, v66
    v_exp_f32 v138, v138
    v_exp_f32 v76, v76
    v_exp_f32 v148, v148
    v_exp_f32 v67, v67
    v_exp_f32 v139, v139
    v_exp_f32 v77, v77
    v_exp_f32 v149, v149
    v_exp_f32 v68, v68
    v_exp_f32 v140, v140
    v_exp_f32 v78, v78
    v_exp_f32 v150, v150
    v_exp_f32 v69, v69
    v_exp_f32 v141, v141
    v_exp_f32 v79, v79
    v_exp_f32 v151, v151
    v_exp_f32 v70, v70
    v_exp_f32 v142, v142
    v_exp_f32 v80, v80
    v_exp_f32 v152, v152
    v_exp_f32 v71, v71
    v_exp_f32 v143, v143
    v_exp_f32 v81, v81
    v_exp_f32 v153, v153
    v_exp_f32 v72, v72
    v_exp_f32 v144, v144
    v_exp_f32 v82, v82
    v_exp_f32 v154, v154
    v_exp_f32 v73, v73
    v_exp_f32 v145, v145
    v_exp_f32 v83, v83
    v_exp_f32 v155, v155
    v_pk_add_f32 v[194:195], v[64:65], v[66:67]
    v_pk_add_f32 v[210:211], v[136:137], v[138:139]
    v_pk_add_f32 v[196:197], v[74:75], v[76:77]
    v_pk_add_f32 v[212:213], v[146:147], v[148:149]
    v_pk_add_f32 v[194:195], v[194:195], v[68:69]
    v_pk_add_f32 v[210:211], v[210:211], v[140:141]
    v_pk_add_f32 v[196:197], v[196:197], v[78:79]
    v_pk_add_f32 v[212:213], v[212:213], v[150:151]
    v_pk_add_f32 v[194:195], v[194:195], v[70:71]
    v_pk_add_f32 v[210:211], v[210:211], v[142:143]
    v_pk_add_f32 v[196:197], v[196:197], v[80:81]
    v_pk_add_f32 v[212:213], v[212:213], v[152:153]
    v_pk_add_f32 v[194:195], v[194:195], v[72:73]
    v_pk_add_f32 v[210:211], v[210:211], v[144:145]
    v_pk_add_f32 v[196:197], v[196:197], v[82:83]
    v_pk_add_f32 v[212:213], v[212:213], v[154:155]
    v_add_f32 v190, v194, v195
    v_add_f32 v206, v210, v211
    v_add_f32 v191, v196, v197
    v_add_f32 v207, v212, v213
    s_nop 0
    v_permlane32_swap_b32 v190, v191
    v_permlane32_swap_b32 v206, v207
    v_add_f32 v190, v190, v191
    v_add_f32 v206, v206, v207
    v_rcp_f32 v192, v190
    v_rcp_f32 v208, v206
    v_mov_b32 v193, v192
    v_mov_b32 v209, v208
    s_nop 0
    v_permlane32_swap_b32 v192, v193
    v_permlane32_swap_b32 v208, v209
    v_pk_mul_f32 v[64:65], v[64:65], v[192:193] op_sel_hi:[1,0]
    v_pk_mul_f32 v[136:137], v[136:137], v[208:209] op_sel_hi:[1,0]
    v_pk_mul_f32 v[74:75], v[74:75], v[192:193] op_sel:[0,1] op_sel_hi:[1,1]
    v_pk_mul_f32 v[146:147], v[146:147], v[208:209] op_sel:[0,1] op_sel_hi:[1,1]
    v_pk_mul_f32 v[66:67], v[66:67], v[192:193] op_sel_hi:[1,0]
    v_pk_mul_f32 v[138:139], v[138:139], v[208:209] op_sel_hi:[1,0]
    v_pk_mul_f32 v[76:77], v[76:77], v[192:193] op_sel:[0,1] op_sel_hi:[1,1]
    v_pk_mul_f32 v[148:149], v[148:149], v[208:209] op_sel:[0,1] op_sel_hi:[1,1]
    v_pk_mul_f32 v[68:69], v[68:69], v[192:193] op_sel_hi:[1,0]
    v_pk_mul_f32 v[140:141], v[140:141], v[208:209] op_sel_hi:[1,0]
    v_pk_mul_f32 v[78:79], v[78:79], v[192:193] op_sel:[0,1] op_sel_hi:[1,1]
    v_pk_mul_f32 v[150:151], v[150:151], v[208:209] op_sel:[0,1] op_sel_hi:[1,1]
    v_pk_mul_f32 v[70:71], v[70:71], v[192:193] op_sel_hi:[1,0]
    v_pk_mul_f32 v[142:143], v[142:143], v[208:209] op_sel_hi:[1,0]
    v_pk_mul_f32 v[80:81], v[80:81], v[192:193] op_sel:[0,1] op_sel_hi:[1,1]
    v_pk_mul_f32 v[152:153], v[152:153], v[208:209] op_sel:[0,1] op_sel_hi:[1,1]
    v_pk_mul_f32 v[72:73], v[72:73], v[192:193] op_sel_hi:[1,0]
    v_pk_mul_f32 v[144:145], v[144:145], v[208:209] op_sel_hi:[1,0]
    v_pk_mul_f32 v[82:83], v[82:83], v[192:193] op_sel:[0,1] op_sel_hi:[1,1]
    v_pk_mul_f32 v[154:155], v[154:155], v[208:209] op_sel:[0,1] op_sel_hi:[1,1]
    v_cvt_pk_bf16_f32 v84, v64, v65
    v_cvt_pk_bf16_f32 v156, v136, v137
    v_cvt_pk_bf16_f32 v89, v74, v75
    v_cvt_pk_bf16_f32 v161, v146, v147
    v_cvt_pk_bf16_f32 v85, v66, v67
    v_cvt_pk_bf16_f32 v157, v138, v139
    v_cvt_pk_bf16_f32 v90, v76, v77
    v_cvt_pk_bf16_f32 v162, v148, v149
    v_cvt_pk_bf16_f32 v86, v68, v69
    v_cvt_pk_bf16_f32 v158, v140, v141
    v_cvt_pk_bf16_f32 v91, v78, v79
    v_cvt_pk_bf16_f32 v163, v150, v151
    v_cvt_pk_bf16_f32 v87, v70, v71
    v_cvt_pk_bf16_f32 v159, v142, v143
    v_cvt_pk_bf16_f32 v92, v80, v81
    v_cvt_pk_bf16_f32 v94, v152, v153
    v_cvt_pk_bf16_f32 v88, v72, v73
    v_cvt_pk_bf16_f32 v160, v144, v145
    v_cvt_pk_bf16_f32 v93, v82, v83
    v_cvt_pk_bf16_f32 v95, v154, v155
    ds_write_b64 v203, v[84:85] offset:20480
    ds_write_b64 v203, v[86:87] offset:20496
    ds_write_b64 v203, v[88:89] offset:20512
    ds_write_b64 v203, v[90:91] offset:20528
    ds_write_b64 v203, v[92:93] offset:20544
    ds_write_b64 v203, v[156:157] offset:30720
    ds_write_b64 v203, v[158:159] offset:30736
    ds_write_b64 v203, v[160:161] offset:30752
    ds_write_b64 v203, v[162:163] offset:30768
    ds_write_b64 v203, v[94:95] offset:30784
    s_waitcnt lgkmcnt(0)
    s_barrier
    v_lshrrev_b32 v190, 5, v200
    v_lshlrev_b32 v190, 3, v190
    v_bfe_u32 v191, v200, 2, 2
    v_add_u32 v190, v190, v191
    v_bfe_u32 v191, v200, 4, 1
    v_lshlrev_b32 v191, 5, v191
    v_and_b32 v192, 3, v200
    v_lshl_add_u32 v191, v192, 3, v191
    v_mul_u32_u24 v192, 80, v190
    v_add_u32 v192, v192, v191
    s_mul_i32 s14, s10, 10240
    v_add_u32 v192, s14, v192
    v_mul_u32_u24 v193, 48, v190
    v_add_u32 v193, v193, v191
    s_mul_i32 s14, s10, 6144
    s_add_u32 s14, s14, 40960
    v_add_u32 v193, s14, v193
    ds_read_b64_tr_b16 v[64:65], v192 offset:0
    ds_read_b64_tr_b16 v[66:67], v192 offset:320
    ds_read_b64_tr_b16 v[68:69], v192 offset:64
    ds_read_b64_tr_b16 v[70:71], v192 offset:384
    ds_read_b64_tr_b16 v[72:73], v193 offset:0
    ds_read_b64_tr_b16 v[74:75], v193 offset:192
    ds_read_b64_tr_b16 v[76:77], v192 offset:1280
    ds_read_b64_tr_b16 v[78:79], v192 offset:1600
    ds_read_b64_tr_b16 v[80:81], v192 offset:1344
    ds_read_b64_tr_b16 v[82:83], v192 offset:1664
    ds_read_b64_tr_b16 v[84:85], v193 offset:768
    ds_read_b64_tr_b16 v[86:87], v193 offset:960
    s_waitcnt lgkmcnt(6)
    v_mfma_f32_32x32x16_bf16 v[0:15], v[64:67], v[72:75], 0
    v_mfma_f32_32x32x16_bf16 v[16:31], v[68:71], v[72:75], 0
    ds_read_b64_tr_b16 v[64:65], v192 offset:2560
    ds_read_b64_tr_b16 v[66:67], v192 offset:2880
    ds_read_b64_tr_b16 v[68:69], v192 offset:2624
    ds_read_b64_tr_b16 v[70:71], v192 offset:2944
    ds_read_b64_tr_b16 v[72:73], v193 offset:1536
    ds_read_b64_tr_b16 v[74:75], v193 offset:1728
    s_waitcnt lgkmcnt(6)
    v_mfma_f32_32x32x16_bf16 v[0:15], v[76:79], v[84:87], v[0:15]
    v_mfma_f32_32x32x16_bf16 v[16:31], v[80:83], v[84:87], v[16:31]
    ds_read_b64_tr_b16 v[76:77], v192 offset:3840
    ds_read_b64_tr_b16 v[78:79], v192 offset:4160
    ds_read_b64_tr_b16 v[80:81], v192 offset:3904
    ds_read_b64_tr_b16 v[82:83], v192 offset:4224
    ds_read_b64_tr_b16 v[84:85], v193 offset:2304
    ds_read_b64_tr_b16 v[86:87], v193 offset:2496
    s_waitcnt lgkmcnt(6)
    v_mfma_f32_32x32x16_bf16 v[0:15], v[64:67], v[72:75], v[0:15]
    v_mfma_f32_32x32x16_bf16 v[16:31], v[68:71], v[72:75], v[16:31]
    ds_read_b64_tr_b16 v[64:65], v192 offset:5120
    ds_read_b64_tr_b16 v[66:67], v192 offset:5440
    ds_read_b64_tr_b16 v[68:69], v192 offset:5184
    ds_read_b64_tr_b16 v[70:71], v192 offset:5504
    ds_read_b64_tr_b16 v[72:73], v193 offset:3072
    ds_read_b64_tr_b16 v[74:75], v193 offset:3264
    s_waitcnt lgkmcnt(6)
    v_mfma_f32_32x32x16_bf16 v[0:15], v[76:79], v[84:87], v[0:15]
    v_mfma_f32_32x32x16_bf16 v[16:31], v[80:83], v[84:87], v[16:31]
    ds_read_b64_tr_b16 v[76:77], v192 offset:6400
    ds_read_b64_tr_b16 v[78:79], v192 offset:6720
    ds_read_b64_tr_b16 v[80:81], v192 offset:6464
    ds_read_b64_tr_b16 v[82:83], v192 offset:6784
    ds_read_b64_tr_b16 v[84:85], v193 offset:3840
    ds_read_b64_tr_b16 v[86:87], v193 offset:4032
    s_waitcnt lgkmcnt(6)
    v_mfma_f32_32x32x16_bf16 v[0:15], v[64:67], v[72:75], v[0:15]
    v_mfma_f32_32x32x16_bf16 v[16:31], v[68:71], v[72:75], v[16:31]
    ds_read_b64_tr_b16 v[64:65], v192 offset:7680
    ds_read_b64_tr_b16 v[66:67], v192 offset:8000
    ds_read_b64_tr_b16 v[68:69], v192 offset:7744
    ds_read_b64_tr_b16 v[70:71], v192 offset:8064
    ds_read_b64_tr_b16 v[72:73], v193 offset:4608
    ds_read_b64_tr_b16 v[74:75], v193 offset:4800
    s_waitcnt lgkmcnt(6)
    v_mfma_f32_32x32x16_bf16 v[0:15], v[76:79], v[84:87], v[0:15]
    v_mfma_f32_32x32x16_bf16 v[16:31], v[80:83], v[84:87], v[16:31]
    ds_read_b64_tr_b16 v[76:77], v192 offset:8960
    ds_read_b64_tr_b16 v[78:79], v192 offset:9280
    ds_read_b64_tr_b16 v[80:81], v192 offset:9024
    ds_read_b64_tr_b16 v[82:83], v192 offset:9344
    ds_read_b64_tr_b16 v[84:85], v193 offset:5376
    ds_read_b64_tr_b16 v[86:87], v193 offset:5568
    s_waitcnt lgkmcnt(6)
    v_mfma_f32_32x32x16_bf16 v[0:15], v[64:67], v[72:75], v[0:15]
    v_mfma_f32_32x32x16_bf16 v[16:31], v[68:71], v[72:75], v[16:31]
    s_waitcnt lgkmcnt(0)
    v_mfma_f32_32x32x16_bf16 v[0:15], v[76:79], v[84:87], v[0:15]
    v_mfma_f32_32x32x16_bf16 v[16:31], v[80:83], v[84:87], v[16:31]
    s_mul_i32 s14, s12, 163840
    s_mul_i32 s15, s10, 5120
    s_add_u32 s14, s14, s15
    s_mul_i32 s15, s13, 20480
    s_add_u32 s14, s14, s15
    s_add_u32 s14, s14, 17825792
    s_add_u32 s34, s4, s14
    s_addc_u32 s35, s5, 0
    s_nop 2
    global_store_dwordx4 v201, v[0:3], s[34:35] offset:0 sc1
    global_store_dwordx4 v201, v[4:7], s[34:35] offset:1024 sc1
    global_store_dwordx4 v201, v[8:11], s[34:35] offset:2048 sc1
    global_store_dwordx4 v201, v[12:15], s[34:35] offset:3072 sc1
    s_add_u32 s34, s34, 4096
    s_addc_u32 s35, s35, 0
    global_store_dwordx4 v201, v[16:19], s[34:35] offset:0 sc1
    s_branch P1_fin
P1_loader:
    s_sub_u32 s10, s10, 4
    v_lshrrev_b32 v202, 3, v200
    v_add_u32 v202, 0, v202
    v_bfe_u32 v203, v202, 1, 3
    v_and_b32 v204, 7, v200
    v_xor_b32 v203, v203, v204
    v_mul_u32_u24 v202, 1280, v202
    v_lshl_add_u32 v206, v203, 4, v202
    v_lshrrev_b32 v202, 3, v200
    v_add_u32 v202, 8, v202
    v_bfe_u32 v203, v202, 1, 3
    v_and_b32 v204, 7, v200
    v_xor_b32 v203, v203, v204
    v_mul_u32_u24 v202, 1280, v202
    v_lshl_add_u32 v207, v203, 4, v202
    v_lshrrev_b32 v202, 3, v200
    v_add_u32 v202, 16, v202
    v_bfe_u32 v203, v202, 1, 3
    v_and_b32 v204, 7, v200
    v_xor_b32 v203, v203, v204
    v_mul_u32_u24 v202, 1280, v202
    v_lshl_add_u32 v208, v203, 4, v202
    v_lshrrev_b32 v202, 3, v200
    v_add_u32 v202, 24, v202
    v_bfe_u32 v203, v202, 1, 3
    v_and_b32 v204, 7, v200
    v_xor_b32 v203, v203, v204
    v_mul_u32_u24 v202, 1280, v202
    v_lshl_add_u32 v209, v203, 4, v202
    s_cmp_lt_u32 s11, 3
    s_mov_b32 s28, 3840
    s_cselect_b32 s28, 1280, s28
    s_cmp_eq_u32 s11, 4
    s_cselect_b32 s15, 1120, 0
    v_mov_b32 v215, s15
    v_add_u32 v202, 0, v200
    v_mul_u32_u24 v203, 3277, v202
    v_lshrrev_b32 v203, 16, v203
    v_mul_u32_u24 v204, 20, v203
    v_sub_u32 v204, v202, v204
    v_cmp_le_u32 vcc, 10, v204
    v_mul_u32_u24 v203, s28, v203
    v_lshl_add_u32 v203, v204, 4, v203
    v_cndmask_b32 v205, 0, v215, vcc
    v_add_u32 v210, v203, v205
    v_add_u32 v202, 64, v200
    v_mul_u32_u24 v203, 3277, v202
    v_lshrrev_b32 v203, 16, v203
    v_mul_u32_u24 v204, 20, v203
    v_sub_u32 v204, v202, v204
    v_cmp_le_u32 vcc, 10, v204
    v_mul_u32_u24 v203, s28, v203
    v_lshl_add_u32 v203, v204, 4, v203
    v_cndmask_b32 v205, 0, v215, vcc
    v_add_u32 v211, v203, v205
    v_add_u32 v202, 128, v200
    v_mul_u32_u24 v203, 3277, v202
    v_lshrrev_b32 v203, 16, v203
    v_mul_u32_u24 v204, 20, v203
    v_sub_u32 v204, v202, v204
    v_cmp_le_u32 vcc, 10, v204
    v_mul_u32_u24 v203, s28, v203
    v_lshl_add_u32 v203, v204, 4, v203
    v_cndmask_b32 v205, 0, v215, vcc
    v_add_u32 v212, v203, v205
    v_add_u32 v202, 192, v200
    v_mul_u32_u24 v203, 3277, v202
    v_lshrrev_b32 v203, 16, v203
    v_mul_u32_u24 v204, 20, v203
    v_sub_u32 v204, v202, v204
    v_cmp_le_u32 vcc, 10, v204
    v_mul_u32_u24 v203, s28, v203
    v_lshl_add_u32 v203, v204, 4, v203
    v_cndmask_b32 v205, 0, v215, vcc
    v_add_u32 v213, v203, v205
    v_add_u32 v202, 256, v200
    v_mul_u32_u24 v203, 3277, v202
    v_lshrrev_b32 v203, 16, v203
    v_mul_u32_u24 v204, 20, v203
    v_sub_u32 v204, v202, v204
    v_cmp_le_u32 vcc, 10, v204
    v_mul_u32_u24 v203, s28, v203
    v_lshl_add_u32 v203, v204, 4, v203
    v_cndmask_b32 v205, 0, v215, vcc
    v_add_u32 v214, v203, v205
    s_waitcnt lgkmcnt(0)
    s_cmp_lt_u32 s11, 3
    s_cselect_b32 s16, s44, s52
    s_cselect_b32 s17, s45, s53
    s_cselect_b32 s18, s46, s54
    s_cselect_b32 s19, s47, s55
    s_lshl_b32 s14, s12, 2
    s_add_u32 s14, s14, s10
    s_mul_i32 s14, s14, 40960
    s_add_u32 s16, s16, s14
    s_addc_u32 s17, s17, 0
    s_mul_i32 s14, s10, s28
    s_lshl_b32 s14, s14, 4
    s_mul_i32 s15, s13, 320
    s_mul_i32 s38, s13, 160
    s_add_u32 s38, s38, 1280
    s_cmp_eq_u32 s11, 4
    s_cselect_b32 s15, s38, s15
    s_add_u32 s14, s14, s15
    s_add_u32 s18, s18, s14
    s_addc_u32 s19, s19, 0
    s_lshl_b32 s28, s28, 6
    s_lshl_b32 s23, s10, 12
    s_mul_i32 s24, s10, 5120
    s_add_u32 s24, s24, 16384
    s_min_u32 s14, s10, 2
    s_lshl_b32 s25, s14, 10
    v_add_u32 v215, s25, v201
    s_add_u32 s25, s25, 147456
    s_cmp_lt_u32 s10, 2
    s_cselect_b32 s37, -1, 0
    s_mov_b32 s36, -1
    s_cmp_eq_u32 s11, 1
    s_cselect_b32 s20, s48, s50
    s_cselect_b32 s21, s49, s51
    s_lshl_b32 s14, s42, 7
    s_add_u32 s16, s16, s14
    s_addc_u32 s17, s17, 0
    s_mul_i32 s14, s42, s28
    s_add_u32 s18, s18, s14
    s_addc_u32 s19, s19, 0
    s_mul_i32 s14, s42, 2560
    s_add_u32 s20, s20, s14
    s_addc_u32 s21, s21, 0
    s_mov_b32 s43, s42
    s_mul_i32 s39, s28, -9
    s_cmp_eq_u32 s11, 1
    s_cbranch_scc1 P1_ldx
    s_cmp_eq_u32 s11, 2
    s_cbranch_scc1 P1_ldx
    s_cmp_lt_u32 s11, 3
    s_cbranch_scc1 P1_ldp
    s_cmp_eq_u32 s11, 3
    s_mov_b32 s14, 3200
    s_cselect_b32 s14, 6400, s14
    s_mul_i32 s14, s14, s13
    s_lshl_b32 s15, s10, 10
    s_add_u32 s15, s15, 0
    s_add_u32 m0, s15, 147456
    s_add_u32 s15, s15, s14
    v_add_u32 v202, s15, v201
    v_min_u32 v202, 25584, v202
    global_load_lds_dwordx4 v202, s[56:57]
    s_lshl_b32 s15, s10, 10
    s_add_u32 s15, s15, 4096
    s_add_u32 m0, s15, 147456
    s_add_u32 s15, s15, s14
    v_add_u32 v202, s15, v201
    v_min_u32 v202, 25584, v202
    global_load_lds_dwordx4 v202, s[56:57]
P1_ldp:
    s_mov_b32 s40, 128
    s_mov_b32 s41, 2560
    s_add_u32 m0, s24, 0
    s_nop 0
    global_load_lds_dwordx4 v210, s[18:19]
    s_add_u32 m0, s24, 1024
    s_nop 0
    global_load_lds_dwordx4 v211, s[18:19]
    s_add_u32 m0, s24, 2048
    s_nop 0
    global_load_lds_dwordx4 v212, s[18:19]
    s_add_u32 m0, s24, 3072
    s_nop 0
    global_load_lds_dwordx4 v213, s[18:19]
    s_add_u32 m0, s24, 4096
    s_nop 0
    global_load_lds_dwordx4 v214, s[18:19]
    s_add_u32 m0, s23, 0
    s_nop 0
    global_load_lds_dwordx4 v206, s[16:17]
    s_add_u32 m0, s23, 1024
    s_nop 0
    global_load_lds_dwordx4 v207, s[16:17]
    s_add_u32 m0, s23, 2048
    s_nop 0
    global_load_lds_dwordx4 v208, s[16:17]
    s_add_u32 m0, s23, 3072
    s_nop 0
    global_load_lds_dwordx4 v209, s[16:17]
    s_add_u32 s43, s43, 1
    s_cmp_eq_u32 s43, 10
    s_cselect_b32 s43, 0, s43
    s_cselect_b32 s14, -1152, s40
    s_cselect_b32 s15, s39, s28
    s_cselect_b32 s38, -23040, s41
    s_ashr_i32 s42, s14, 31
    s_add_u32 s16, s16, s14
    s_addc_u32 s17, s17, s42
    s_add_u32 s18, s18, s15
    s_addc_u32 s19, s19, s42
    s_add_u32 m0, s24, 36864
    s_nop 0
    global_load_lds_dwordx4 v210, s[18:19]
    s_add_u32 m0, s24, 37888
    s_nop 0
    global_load_lds_dwordx4 v211, s[18:19]
    s_add_u32 m0, s24, 38912
    s_nop 0
    global_load_lds_dwordx4 v212, s[18:19]
    s_add_u32 m0, s24, 39936
    s_nop 0
    global_load_lds_dwordx4 v213, s[18:19]
    s_add_u32 m0, s24, 40960
    s_nop 0
    global_load_lds_dwordx4 v214, s[18:19]
    s_add_u32 m0, s23, 36864
    s_nop 0
    global_load_lds_dwordx4 v206, s[16:17]
    s_add_u32 m0, s23, 37888
    s_nop 0
    global_load_lds_dwordx4 v207, s[16:17]
    s_add_u32 m0, s23, 38912
    s_nop 0
    global_load_lds_dwordx4 v208, s[16:17]
    s_add_u32 m0, s23, 39936
    s_nop 0
    global_load_lds_dwordx4 v209, s[16:17]
    s_waitcnt vmcnt(9)
    s_barrier
    s_add_u32 s43, s43, 1
    s_cmp_eq_u32 s43, 10
    s_cselect_b32 s43, 0, s43
    s_cselect_b32 s14, -1152, s40
    s_cselect_b32 s15, s39, s28
    s_cselect_b32 s38, -23040, s41
    s_ashr_i32 s42, s14, 31
    s_add_u32 s16, s16, s14
    s_addc_u32 s17, s17, s42
    s_add_u32 s18, s18, s15
    s_addc_u32 s19, s19, s42
    s_add_u32 m0, s24, 73728
    s_nop 0
    global_load_lds_dwordx4 v210, s[18:19]
    s_add_u32 m0, s24, 74752
    s_nop 0
    global_load_lds_dwordx4 v211, s[18:19]
    s_add_u32 m0, s24, 75776
    s_nop 0
    global_load_lds_dwordx4 v212, s[18:19]
    s_add_u32 m0, s24, 76800
    s_nop 0
    global_load_lds_dwordx4 v213, s[18:19]
    s_add_u32 m0, s24, 77824
    s_nop 0
    global_load_lds_dwordx4 v214, s[18:19]
    s_add_u32 m0, s23, 73728
    s_nop 0
    global_load_lds_dwordx4 v206, s[16:17]
    s_add_u32 m0, s23, 74752
    s_nop 0
    global_load_lds_dwordx4 v207, s[16:17]
    s_add_u32 m0, s23, 75776
    s_nop 0
    global_load_lds_dwordx4 v208, s[16:17]
    s_add_u32 m0, s23, 76800
    s_nop 0
    global_load_lds_dwordx4 v209, s[16:17]
    s_waitcnt vmcnt(9)
    s_barrier
    s_add_u32 s43, s43, 1
    s_cmp_eq_u32 s43, 10
    s_cselect_b32 s43, 0, s43
    s_cselect_b32 s14, -1152, s40
    s_cselect_b32 s15, s39, s28
    s_cselect_b32 s38, -23040, s41
    s_ashr_i32 s42, s14, 31
    s_add_u32 s16, s16, s14
    s_addc_u32 s17, s17, s42
    s_add_u32 s18, s18, s15
    s_addc_u32 s19, s19, s42
    s_add_u32 m0, s24, 110592
    s_nop 0
    global_load_lds_dwordx4 v210, s[18:19]
    s_add_u32 m0, s24, 111616
    s_nop 0
    global_load_lds_dwordx4 v211, s[18:19]
    s_add_u32 m0, s24, 112640
    s_nop 0
    global_load_lds_dwordx4 v212, s[18:19]
    s_add_u32 m0, s24, 113664
    s_nop 0
    global_load_lds_dwordx4 v213, s[18:19]
    s_add_u32 m0, s24, 114688
    s_nop 0
    global_load_lds_dwordx4 v214, s[18:19]
    s_add_u32 m0, s23, 110592
    s_nop 0
    global_load_lds_dwordx4 v206, s[16:17]
    s_add_u32 m0, s23, 111616
    s_nop 0
    global_load_lds_dwordx4 v207, s[16:17]
    s_add_u32 m0, s23, 112640
    s_nop 0
    global_load_lds_dwordx4 v208, s[16:17]
    s_add_u32 m0, s23, 113664
    s_nop 0
    global_load_lds_dwordx4 v209, s[16:17]
    s_waitcnt vmcnt(9)
    s_barrier
    s_add_u32 s43, s43, 1
    s_cmp_eq_u32 s43, 10
    s_cselect_b32 s43, 0, s43
    s_cselect_b32 s14, -1152, s40
    s_cselect_b32 s15, s39, s28
    s_cselect_b32 s38, -23040, s41
    s_ashr_i32 s42, s14, 31
    s_add_u32 s16, s16, s14
    s_addc_u32 s17, s17, s42
    s_add_u32 s18, s18, s15
    s_addc_u32 s19, s19, s42
    s_add_u32 m0, s24, 0
    s_nop 0
    global_load_lds_dwordx4 v210, s[18:19]
    s_add_u32 m0, s24, 1024
    s_nop 0
    global_load_lds_dwordx4 v211, s[18:19]
    s_add_u32 m0, s24, 2048
    s_nop 0
    global_load_lds_dwordx4 v212, s[18:19]
    s_add_u32 m0, s24, 3072
    s_nop 0
    global_load_lds_dwordx4 v213, s[18:19]
    s_add_u32 m0, s24, 4096
    s_nop 0
    global_load_lds_dwordx4 v214, s[18:19]
    s_add_u32 m0, s23, 0
    s_nop 0
    global_load_lds_dwordx4 v206, s[16:17]
    s_add_u32 m0, s23, 1024
    s_nop 0
    global_load_lds_dwordx4 v207, s[16:17]
    s_add_u32 m0, s23, 2048
    s_nop 0
    global_load_lds_dwordx4 v208, s[16:17]
    s_add_u32 m0, s23, 3072
    s_nop 0
    global_load_lds_dwordx4 v209, s[16:17]
    s_waitcnt vmcnt(9)
    s_barrier
    s_add_u32 s43, s43, 1
    s_cmp_eq_u32 s43, 10
    s_cselect_b32 s43, 0, s43
    s_cselect_b32 s14, -1152, s40
    s_cselect_b32 s15, s39, s28
    s_cselect_b32 s38, -23040, s41
    s_ashr_i32 s42, s14, 31
    s_add_u32 s16, s16, s14
    s_addc_u32 s17, s17, s42
    s_add_u32 s18, s18, s15
    s_addc_u32 s19, s19, s42
    s_add_u32 m0, s24, 36864
    s_nop 0
    global_load_lds_dwordx4 v210, s[18:19]
    s_add_u32 m0, s24, 37888
    s_nop 0
    global_load_lds_dwordx4 v211, s[18:19]
    s_add_u32 m0, s24, 38912
    s_nop 0
    global_load_lds_dwordx4 v212, s[18:19]
    s_add_u32 m0, s24, 39936
    s_nop 0
    global_load_lds_dwordx4 v213, s[18:19]
    s_add_u32 m0, s24, 40960
    s_nop 0
    global_load_lds_dwordx4 v214, s[18:19]
    s_add_u32 m0, s23, 36864
    s_nop 0
    global_load_lds_dwordx4 v206, s[16:17]
    s_add_u32 m0, s23, 37888
    s_nop 0
    global_load_lds_dwordx4 v207, s[16:17]
    s_add_u32 m0, s23, 38912
    s_nop 0
    global_load_lds_dwordx4 v208, s[16:17]
    s_add_u32 m0, s23, 39936
    s_nop 0
    global_load_lds_dwordx4 v209, s[16:17]
    s_waitcnt vmcnt(9)
    s_barrier
    s_add_u32 s43, s43, 1
    s_cmp_eq_u32 s43, 10
    s_cselect_b32 s43, 0, s43
    s_cselect_b32 s14, -1152, s40
    s_cselect_b32 s15, s39, s28
    s_cselect_b32 s38, -23040, s41
    s_ashr_i32 s42, s14, 31
    s_add_u32 s16, s16, s14
    s_addc_u32 s17, s17, s42
    s_add_u32 s18, s18, s15
    s_addc_u32 s19, s19, s42
    s_add_u32 m0, s24, 73728
    s_nop 0
    global_load_lds_dwordx4 v210, s[18:19]
    s_add_u32 m0, s24, 74752
    s_nop 0
    global_load_lds_dwordx4 v211, s[18:19]
    s_add_u32 m0, s24, 75776
    s_nop 0
    global_load_lds_dwordx4 v212, s[18:19]
    s_add_u32 m0, s24, 76800
    s_nop 0
    global_load_lds_dwordx4 v213, s[18:19]
    s_add_u32 m0, s24, 77824
    s_nop 0
    global_load_lds_dwordx4 v214, s[18:19]
    s_add_u32 m0, s23, 73728
    s_nop 0
    global_load_lds_dwordx4 v206, s[16:17]
    s_add_u32 m0, s23, 74752
    s_nop 0
    global_load_lds_dwordx4 v207, s[16:17]
    s_add_u32 m0, s23, 75776
    s_nop 0
    global_load_lds_dwordx4 v208, s[16:17]
    s_add_u32 m0, s23, 76800
    s_nop 0
    global_load_lds_dwordx4 v209, s[16:17]
    s_waitcnt vmcnt(9)
    s_barrier
    s_add_u32 s43, s43, 1
    s_cmp_eq_u32 s43, 10
    s_cselect_b32 s43, 0, s43
    s_cselect_b32 s14, -1152, s40
    s_cselect_b32 s15, s39, s28
    s_cselect_b32 s38, -23040, s41
    s_ashr_i32 s42, s14, 31
    s_add_u32 s16, s16, s14
    s_addc_u32 s17, s17, s42
    s_add_u32 s18, s18, s15
    s_addc_u32 s19, s19, s42
    s_add_u32 m0, s24, 110592
    s_nop 0
    global_load_lds_dwordx4 v210, s[18:19]
    s_add_u32 m0, s24, 111616
    s_nop 0
    global_load_lds_dwordx4 v211, s[18:19]
    s_add_u32 m0, s24, 112640
    s_nop 0
    global_load_lds_dwordx4 v212, s[18:19]
    s_add_u32 m0, s24, 113664
    s_nop 0
    global_load_lds_dwordx4 v213, s[18:19]
    s_add_u32 m0, s24, 114688
    s_nop 0
    global_load_lds_dwordx4 v214, s[18:19]
    s_add_u32 m0, s23, 110592
    s_nop 0
    global_load_lds_dwordx4 v206, s[16:17]
    s_add_u32 m0, s23, 111616
    s_nop 0
    global_load_lds_dwordx4 v207, s[16:17]
    s_add_u32 m0, s23, 112640
    s_nop 0
    global_load_lds_dwordx4 v208, s[16:17]
    s_add_u32 m0, s23, 113664
    s_nop 0
    global_load_lds_dwordx4 v209, s[16:17]
    s_waitcnt vmcnt(9)
    s_barrier
    s_add_u32 s43, s43, 1
    s_cmp_eq_u32 s43, 10
    s_cselect_b32 s43, 0, s43
    s_cselect_b32 s14, -1152, s40
    s_cselect_b32 s15, s39, s28
    s_cselect_b32 s38, -23040, s41
    s_ashr_i32 s42, s14, 31
    s_add_u32 s16, s16, s14
    s_addc_u32 s17, s17, s42
    s_add_u32 s18, s18, s15
    s_addc_u32 s19, s19, s42
    s_add_u32 m0, s24, 0
    s_nop 0
    global_load_lds_dwordx4 v210, s[18:19]
    s_add_u32 m0, s24, 1024
    s_nop 0
    global_load_lds_dwordx4 v211, s[18:19]
    s_add_u32 m0, s24, 2048
    s_nop 0
    global_load_lds_dwordx4 v212, s[18:19]
    s_add_u32 m0, s24, 3072
    s_nop 0
    global_load_lds_dwordx4 v213, s[18:19]
    s_add_u32 m0, s24, 4096
    s_nop 0
    global_load_lds_dwordx4 v214, s[18:19]
    s_add_u32 m0, s23, 0
    s_nop 0
    global_load_lds_dwordx4 v206, s[16:17]
    s_add_u32 m0, s23, 1024
    s_nop 0
    global_load_lds_dwordx4 v207, s[16:17]
    s_add_u32 m0, s23, 2048
    s_nop 0
    global_load_lds_dwordx4 v208, s[16:17]
    s_add_u32 m0, s23, 3072
    s_nop 0
    global_load_lds_dwordx4 v209, s[16:17]
    s_waitcnt vmcnt(9)
    s_barrier
    s_add_u32 s43, s43, 1
    s_cmp_eq_u32 s43, 10
    s_cselect_b32 s43, 0, s43
    s_cselect_b32 s14, -1152, s40
    s_cselect_b32 s15, s39, s28
    s_cselect_b32 s38, -23040, s41
    s_ashr_i32 s42, s14, 31
    s_add_u32 s16, s16, s14
    s_addc_u32 s17, s17, s42
    s_add_u32 s18, s18, s15
    s_addc_u32 s19, s19, s42
    s_add_u32 m0, s24, 36864
    s_nop 0
    global_load_lds_dwordx4 v210, s[18:19]
    s_add_u32 m0, s24, 37888
    s_nop 0
    global_load_lds_dwordx4 v211, s[18:19]
    s_add_u32 m0, s24, 38912
    s_nop 0
    global_load_lds_dwordx4 v212, s[18:19]
    s_add_u32 m0, s24, 39936
    s_nop 0
    global_load_lds_dwordx4 v213, s[18:19]
    s_add_u32 m0, s24, 40960
    s_nop 0
    global_load_lds_dwordx4 v214, s[18:19]
    s_add_u32 m0, s23, 36864
    s_nop 0
    global_load_lds_dwordx4 v206, s[16:17]
    s_add_u32 m0, s23, 37888
    s_nop 0
    global_load_lds_dwordx4 v207, s[16:17]
    s_add_u32 m0, s23, 38912
    s_nop 0
    global_load_lds_dwordx4 v208, s[16:17]
    s_add_u32 m0, s23, 39936
    s_nop 0
    global_load_lds_dwordx4 v209, s[16:17]
    s_waitcnt vmcnt(9)
    s_barrier
    s_waitcnt vmcnt(0)
    s_barrier
    s_barrier
    s_branch P1_ldend
P1_ldx:
    s_mov_b32 s40, 128
    s_mov_b32 s41, 2560
    s_add_u32 m0, s24, 0
    s_nop 0
    global_load_lds_dwordx4 v210, s[18:19]
    s_add_u32 m0, s24, 1024
    s_nop 0
    global_load_lds_dwordx4 v211, s[18:19]
    s_add_u32 m0, s24, 2048
    s_nop 0
    global_load_lds_dwordx4 v212, s[18:19]
    s_add_u32 m0, s24, 3072
    s_nop 0
    global_load_lds_dwordx4 v213, s[18:19]
    s_add_u32 m0, s24, 4096
    s_nop 0
    global_load_lds_dwordx4 v214, s[18:19]
    s_add_u32 m0, s23, 0
    s_nop 0
    global_load_lds_dwordx4 v206, s[16:17]
    s_add_u32 m0, s23, 1024
    s_nop 0
    global_load_lds_dwordx4 v207, s[16:17]
    s_add_u32 m0, s23, 2048
    s_nop 0
    global_load_lds_dwordx4 v208, s[16:17]
    s_add_u32 m0, s23, 3072
    s_nop 0
    global_load_lds_dwordx4 v209, s[16:17]
    s_add_u32 m0, s25, 0
    s_mov_b64 exec, s[36:37]
    global_load_lds_dwordx4 v215, s[20:21]
    s_mov_b64 exec, -1
    s_add_u32 s43, s43, 1
    s_cmp_eq_u32 s43, 10
    s_cselect_b32 s43, 0, s43
    s_cselect_b32 s14, -1152, s40
    s_cselect_b32 s15, s39, s28
    s_cselect_b32 s38, -23040, s41
    s_ashr_i32 s42, s14, 31
    s_add_u32 s16, s16, s14
    s_addc_u32 s17, s17, s42
    s_add_u32 s18, s18, s15
    s_addc_u32 s19, s19, s42
    s_add_u32 m0, s24, 36864
    s_nop 0
    global_load_lds_dwordx4 v210, s[18:19]
    s_add_u32 m0, s24, 37888
    s_nop 0
    global_load_lds_dwordx4 v211, s[18:19]
    s_add_u32 m0, s24, 38912
    s_nop 0
    global_load_lds_dwordx4 v212, s[18:19]
    s_add_u32 m0, s24, 39936
    s_nop 0
    global_load_lds_dwordx4 v213, s[18:19]
    s_add_u32 m0, s24, 40960
    s_nop 0
    global_load_lds_dwordx4 v214, s[18:19]
    s_add_u32 m0, s23, 36864
    s_nop 0
    global_load_lds_dwordx4 v206, s[16:17]
    s_add_u32 m0, s23, 37888
    s_nop 0
    global_load_lds_dwordx4 v207, s[16:17]
    s_add_u32 m0, s23, 38912
    s_nop 0
    global_load_lds_dwordx4 v208, s[16:17]
    s_add_u32 m0, s23, 39936
    s_nop 0
    global_load_lds_dwordx4 v209, s[16:17]
    s_add_u32 s20, s20, s38
    s_addc_u32 s21, s21, s42
    s_add_u32 m0, s25, 2560
    s_mov_b64 exec, s[36:37]
    global_load_lds_dwordx4 v215, s[20:21]
    s_mov_b64 exec, -1
    s_waitcnt vmcnt(10)
    s_barrier
    s_add_u32 s43, s43, 1
    s_cmp_eq_u32 s43, 10
    s_cselect_b32 s43, 0, s43
    s_cselect_b32 s14, -1152, s40
    s_cselect_b32 s15, s39, s28
    s_cselect_b32 s38, -23040, s41
    s_ashr_i32 s42, s14, 31
    s_add_u32 s16, s16, s14
    s_addc_u32 s17, s17, s42
    s_add_u32 s18, s18, s15
    s_addc_u32 s19, s19, s42
    s_add_u32 m0, s24, 73728
    s_nop 0
    global_load_lds_dwordx4 v210, s[18:19]
    s_add_u32 m0, s24, 74752
    s_nop 0
    global_load_lds_dwordx4 v211, s[18:19]
    s_add_u32 m0, s24, 75776
    s_nop 0
    global_load_lds_dwordx4 v212, s[18:19]
    s_add_u32 m0, s24, 76800
    s_nop 0
    global_load_lds_dwordx4 v213, s[18:19]
    s_add_u32 m0, s24, 77824
    s_nop 0
    global_load_lds_dwordx4 v214, s[18:19]
    s_add_u32 m0, s23, 73728
    s_nop 0
    global_load_lds_dwordx4 v206, s[16:17]
    s_add_u32 m0, s23, 74752
    s_nop 0
    global_load_lds_dwordx4 v207, s[16:17]
    s_add_u32 m0, s23, 75776
    s_nop 0
    global_load_lds_dwordx4 v208, s[16:17]
    s_add_u32 m0, s23, 76800
    s_nop 0
    global_load_lds_dwordx4 v209, s[16:17]
    s_add_u32 s20, s20, s38
    s_addc_u32 s21, s21, s42
    s_add_u32 m0, s25, 5120
    s_mov_b64 exec, s[36:37]
    global_load_lds_dwordx4 v215, s[20:21]
    s_mov_b64 exec, -1
    s_waitcnt vmcnt(10)
    s_barrier
    s_add_u32 s43, s43, 1
    s_cmp_eq_u32 s43, 10
    s_cselect_b32 s43, 0, s43
    s_cselect_b32 s14, -1152, s40
    s_cselect_b32 s15, s39, s28
    s_cselect_b32 s38, -23040, s41
    s_ashr_i32 s42, s14, 31
    s_add_u32 s16, s16, s14
    s_addc_u32 s17, s17, s42
    s_add_u32 s18, s18, s15
    s_addc_u32 s19, s19, s42
    s_add_u32 m0, s24, 110592
    s_nop 0
    global_load_lds_dwordx4 v210, s[18:19]
    s_add_u32 m0, s24, 111616
    s_nop 0
    global_load_lds_dwordx4 v211, s[18:19]
    s_add_u32 m0, s24, 112640
    s_nop 0
    global_load_lds_dwordx4 v212, s[18:19]
    s_add_u32 m0, s24, 113664
    s_nop 0
    global_load_lds_dwordx4 v213, s[18:19]
    s_add_u32 m0, s24, 114688
    s_nop 0
    global_load_lds_dwordx4 v214, s[18:19]
    s_add_u32 m0, s23, 110592
    s_nop 0
    global_load_lds_dwordx4 v206, s[16:17]
    s_add_u32 m0, s23, 111616
    s_nop 0
    global_load_lds_dwordx4 v207, s[16:17]
    s_add_u32 m0, s23, 112640
    s_nop 0
    global_load_lds_dwordx4 v208, s[16:17]
    s_add_u32 m0, s23, 113664
    s_nop 0
    global_load_lds_dwordx4 v209, s[16:17]
    s_add_u32 s20, s20, s38
    s_addc_u32 s21, s21, s42
    s_add_u32 m0, s25, 7680
    s_mov_b64 exec, s[36:37]
    global_load_lds_dwordx4 v215, s[20:21]
    s_mov_b64 exec, -1
    s_waitcnt vmcnt(10)
    s_barrier
    s_add_u32 s43, s43, 1
    s_cmp_eq_u32 s43, 10
    s_cselect_b32 s43, 0, s43
    s_cselect_b32 s14, -1152, s40
    s_cselect_b32 s15, s39, s28
    s_cselect_b32 s38, -23040, s41
    s_ashr_i32 s42, s14, 31
    s_add_u32 s16, s16, s14
    s_addc_u32 s17, s17, s42
    s_add_u32 s18, s18, s15
    s_addc_u32 s19, s19, s42
    s_add_u32 m0, s24, 0
    s_nop 0
    global_load_lds_dwordx4 v210, s[18:19]
    s_add_u32 m0, s24, 1024
    s_nop 0
    global_load_lds_dwordx4 v211, s[18:19]
    s_add_u32 m0, s24, 2048
    s_nop 0
    global_load_lds_dwordx4 v212, s[18:19]
    s_add_u32 m0, s24, 3072
    s_nop 0
    global_load_lds_dwordx4 v213, s[18:19]
    s_add_u32 m0, s24, 4096
    s_nop 0
    global_load_lds_dwordx4 v214, s[18:19]
    s_add_u32 m0, s23, 0
    s_nop 0
    global_load_lds_dwordx4 v206, s[16:17]
    s_add_u32 m0, s23, 1024
    s_nop 0
    global_load_lds_dwordx4 v207, s[16:17]
    s_add_u32 m0, s23, 2048
    s_nop 0
    global_load_lds_dwordx4 v208, s[16:17]
    s_add_u32 m0, s23, 3072
    s_nop 0
    global_load_lds_dwordx4 v209, s[16:17]
    s_add_u32 s20, s20, s38
    s_addc_u32 s21, s21, s42
    s_add_u32 m0, s25, 0
    s_mov_b64 exec, s[36:37]
    global_load_lds_dwordx4 v215, s[20:21]
    s_mov_b64 exec, -1
    s_waitcnt vmcnt(10)
    s_barrier
    s_add_u32 s43, s43, 1
    s_cmp_eq_u32 s43, 10
    s_cselect_b32 s43, 0, s43
    s_cselect_b32 s14, -1152, s40
    s_cselect_b32 s15, s39, s28
    s_cselect_b32 s38, -23040, s41
    s_ashr_i32 s42, s14, 31
    s_add_u32 s16, s16, s14
    s_addc_u32 s17, s17, s42
    s_add_u32 s18, s18, s15
    s_addc_u32 s19, s19, s42
    s_add_u32 m0, s24, 36864
    s_nop 0
    global_load_lds_dwordx4 v210, s[18:19]
    s_add_u32 m0, s24, 37888
    s_nop 0
    global_load_lds_dwordx4 v211, s[18:19]
    s_add_u32 m0, s24, 38912
    s_nop 0
    global_load_lds_dwordx4 v212, s[18:19]
    s_add_u32 m0, s24, 39936
    s_nop 0
    global_load_lds_dwordx4 v213, s[18:19]
    s_add_u32 m0, s24, 40960
    s_nop 0
    global_load_lds_dwordx4 v214, s[18:19]
    s_add_u32 m0, s23, 36864
    s_nop 0
    global_load_lds_dwordx4 v206, s[16:17]
    s_add_u32 m0, s23, 37888
    s_nop 0
    global_load_lds_dwordx4 v207, s[16:17]
    s_add_u32 m0, s23, 38912
    s_nop 0
    global_load_lds_dwordx4 v208, s[16:17]
    s_add_u32 m0, s23, 39936
    s_nop 0
    global_load_lds_dwordx4 v209, s[16:17]
    s_add_u32 s20, s20, s38
    s_addc_u32 s21, s21, s42
    s_add_u32 m0, s25, 2560
    s_mov_b64 exec, s[36:37]
    global_load_lds_dwordx4 v215, s[20:21]
    s_mov_b64 exec, -1
    s_waitcnt vmcnt(10)
    s_barrier
    s_add_u32 s43, s43, 1
    s_cmp_eq_u32 s43, 10
    s_cselect_b32 s43, 0, s43
    s_cselect_b32 s14, -1152, s40
    s_cselect_b32 s15, s39, s28
    s_cselect_b32 s38, -23040, s41
    s_ashr_i32 s42, s14, 31
    s_add_u32 s16, s16, s14
    s_addc_u32 s17, s17, s42
    s_add_u32 s18, s18, s15
    s_addc_u32 s19, s19, s42
    s_add_u32 m0, s24, 73728
    s_nop 0
    global_load_lds_dwordx4 v210, s[18:19]
    s_add_u32 m0, s24, 74752
    s_nop 0
    global_load_lds_dwordx4 v211, s[18:19]
    s_add_u32 m0, s24, 75776
    s_nop 0
    global_load_lds_dwordx4 v212, s[18:19]
    s_add_u32 m0, s24, 76800
    s_nop 0
    global_load_lds_dwordx4 v213, s[18:19]
    s_add_u32 m0, s24, 77824
    s_nop 0
    global_load_lds_dwordx4 v214, s[18:19]
    s_add_u32 m0, s23, 73728
    s_nop 0
    global_load_lds_dwordx4 v206, s[16:17]
    s_add_u32 m0, s23, 74752
    s_nop 0
    global_load_lds_dwordx4 v207, s[16:17]
    s_add_u32 m0, s23, 75776
    s_nop 0
    global_load_lds_dwordx4 v208, s[16:17]
    s_add_u32 m0, s23, 76800
    s_nop 0
    global_load_lds_dwordx4 v209, s[16:17]
    s_add_u32 s20, s20, s38
    s_addc_u32 s21, s21, s42
    s_add_u32 m0, s25, 5120
    s_mov_b64 exec, s[36:37]
    global_load_lds_dwordx4 v215, s[20:21]
    s_mov_b64 exec, -1
    s_waitcnt vmcnt(10)
    s_barrier
    s_add_u32 s43, s43, 1
    s_cmp_eq_u32 s43, 10
    s_cselect_b32 s43, 0, s43
    s_cselect_b32 s14, -1152, s40
    s_cselect_b32 s15, s39, s28
    s_cselect_b32 s38, -23040, s41
    s_ashr_i32 s42, s14, 31
    s_add_u32 s16, s16, s14
    s_addc_u32 s17, s17, s42
    s_add_u32 s18, s18, s15
    s_addc_u32 s19, s19, s42
    s_add_u32 m0, s24, 110592
    s_nop 0
    global_load_lds_dwordx4 v210, s[18:19]
    s_add_u32 m0, s24, 111616
    s_nop 0
    global_load_lds_dwordx4 v211, s[18:19]
    s_add_u32 m0, s24, 112640
    s_nop 0
    global_load_lds_dwordx4 v212, s[18:19]
    s_add_u32 m0, s24, 113664
    s_nop 0
    global_load_lds_dwordx4 v213, s[18:19]
    s_add_u32 m0, s24, 114688
    s_nop 0
    global_load_lds_dwordx4 v214, s[18:19]
    s_add_u32 m0, s23, 110592
    s_nop 0
    global_load_lds_dwordx4 v206, s[16:17]
    s_add_u32 m0, s23, 111616
    s_nop 0
    global_load_lds_dwordx4 v207, s[16:17]
    s_add_u32 m0, s23, 112640
    s_nop 0
    global_load_lds_dwordx4 v208, s[16:17]
    s_add_u32 m0, s23, 113664
    s_nop 0
    global_load_lds_dwordx4 v209, s[16:17]
    s_add_u32 s20, s20, s38
    s_addc_u32 s21, s21, s42
    s_add_u32 m0, s25, 7680
    s_mov_b64 exec, s[36:37]
    global_load_lds_dwordx4 v215, s[20:21]
    s_mov_b64 exec, -1
    s_waitcnt vmcnt(10)
    s_barrier
    s_add_u32 s43, s43, 1
    s_cmp_eq_u32 s43, 10
    s_cselect_b32 s43, 0, s43
    s_cselect_b32 s14, -1152, s40
    s_cselect_b32 s15, s39, s28
    s_cselect_b32 s38, -23040, s41
    s_ashr_i32 s42, s14, 31
    s_add_u32 s16, s16, s14
    s_addc_u32 s17, s17, s42
    s_add_u32 s18, s18, s15
    s_addc_u32 s19, s19, s42
    s_add_u32 m0, s24, 0
    s_nop 0
    global_load_lds_dwordx4 v210, s[18:19]
    s_add_u32 m0, s24, 1024
    s_nop 0
    global_load_lds_dwordx4 v211, s[18:19]
    s_add_u32 m0, s24, 2048
    s_nop 0
    global_load_lds_dwordx4 v212, s[18:19]
    s_add_u32 m0, s24, 3072
    s_nop 0
    global_load_lds_dwordx4 v213, s[18:19]
    s_add_u32 m0, s24, 4096
    s_nop 0
    global_load_lds_dwordx4 v214, s[18:19]
    s_add_u32 m0, s23, 0
    s_nop 0
    global_load_lds_dwordx4 v206, s[16:17]
    s_add_u32 m0, s23, 1024
    s_nop 0
    global_load_lds_dwordx4 v207, s[16:17]
    s_add_u32 m0, s23, 2048
    s_nop 0
    global_load_lds_dwordx4 v208, s[16:17]
    s_add_u32 m0, s23, 3072
    s_nop 0
    global_load_lds_dwordx4 v209, s[16:17]
    s_add_u32 s20, s20, s38
    s_addc_u32 s21, s21, s42
    s_add_u32 m0, s25, 0
    s_mov_b64 exec, s[36:37]
    global_load_lds_dwordx4 v215, s[20:21]
    s_mov_b64 exec, -1
    s_waitcnt vmcnt(10)
    s_barrier
    s_add_u32 s43, s43, 1
    s_cmp_eq_u32 s43, 10
    s_cselect_b32 s43, 0, s43
    s_cselect_b32 s14, -1152, s40
    s_cselect_b32 s15, s39, s28
    s_cselect_b32 s38, -23040, s41
    s_ashr_i32 s42, s14, 31
    s_add_u32 s16, s16, s14
    s_addc_u32 s17, s17, s42
    s_add_u32 s18, s18, s15
    s_addc_u32 s19, s19, s42
    s_add_u32 m0, s24, 36864
    s_nop 0
    global_load_lds_dwordx4 v210, s[18:19]
    s_add_u32 m0, s24, 37888
    s_nop 0
    global_load_lds_dwordx4 v211, s[18:19]
    s_add_u32 m0, s24, 38912
    s_nop 0
    global_load_lds_dwordx4 v212, s[18:19]
    s_add_u32 m0, s24, 39936
    s_nop 0
    global_load_lds_dwordx4 v213, s[18:19]
    s_add_u32 m0, s24, 40960
    s_nop 0
    global_load_lds_dwordx4 v214, s[18:19]
    s_add_u32 m0, s23, 36864
    s_nop 0
    global_load_lds_dwordx4 v206, s[16:17]
    s_add_u32 m0, s23, 37888
    s_nop 0
    global_load_lds_dwordx4 v207, s[16:17]
    s_add_u32 m0, s23, 38912
    s_nop 0
    global_load_lds_dwordx4 v208, s[16:17]
    s_add_u32 m0, s23, 39936
    s_nop 0
    global_load_lds_dwordx4 v209, s[16:17]
    s_add_u32 s20, s20, s38
    s_addc_u32 s21, s21, s42
    s_add_u32 m0, s25, 2560
    s_mov_b64 exec, s[36:37]
    global_load_lds_dwordx4 v215, s[20:21]
    s_mov_b64 exec, -1
    s_waitcnt vmcnt(10)
    s_barrier
    s_waitcnt vmcnt(0)
    s_barrier
    s_barrier
    s_branch P1_ldend
P1_ldend:
    s_load_dwordx2 s[44:45], s[0:1], 32
    s_load_dwordx2 s[46:47], s[0:1], 64
    s_lshr_b32 s14, s2, 3
    s_mul_i32 s14, s14, 200
    s_lshl_b32 s15, s10, 6
    s_add_u32 s14, s14, s15
    v_add_u32 v202, s14, v200
    v_min_u32 v202, 6399, v202
    v_lshlrev_b32 v202, 7, v202
    s_and_b32 s14, s2, 4
    s_cmp_eq_u32 s14, 0
    s_waitcnt lgkmcnt(0)
    s_cselect_b32 s44, s44, s46
    s_cselect_b32 s45, s45, s47
    global_load_dword v203, v202, s[44:45]
    s_sub_u32 s14, s11, 1
    s_cmp_lt_u32 s14, 2
    s_cbranch_scc0 P1_ld4
    s_barrier
P1_ld4:
    s_cmp_eq_u32 s11, 4
    s_cbranch_scc0 P1_fin
    s_barrier
    s_barrier
P1_fin:
    s_cmp_eq_u32 s96, 4
    s_cbranch_scc0 P1_nodep
    s_lshr_b32 s60, s2, 4
    s_lshl_b32 s60, s60, 2
    s_and_b32 s61, s2, 3
    s_add_u32 s60, s60, s61
    s_lshl_b32 s60, s60, 7
    s_add_u32 s60, s60, 22037504
    s_lshl_b32 s61, s61, 12
    s_add_u32 s61, s61, 22070272
    v_lshlrev_b32 v234, 7, v228
    v_add_u32 v234, s61, v234
    v_mov_b32 v232, s60
    v_cmp_gt_u32 vcc, 32, v228
    s_nop 1
    v_cndmask_b32 v232, v232, v234, vcc
    global_load_dword v234, v232, s[4:5] sc1
P1_nodep:
    s_lshl_b32 s14, s12, 2
    s_add_u32 s14, s14, s13
    s_lshl_b32 s14, s14, 7
    s_add_u32 s15, s14, 22037504
    s_add_u32 s38, s14, 22045696
    s_lshl_b32 s39, s13, 7
    s_add_u32 s39, s39, 22021120
    s_cmp_eq_u32 s11, 3
    s_cselect_b32 s15, s38, s15
    s_cmp_eq_u32 s11, 4
    s_cselect_b32 s51, s39, s15
    s_mov_b32 s50, s11
    s_cmp_ge_u32 s11, 3
    s_cbranch_scc1 P1_sigdone
    s_waitcnt vmcnt(0) lgkmcnt(0)
    s_barrier
    s_cmp_eq_u32 s96, 1
    s_cbranch_scc0 P1_sigdone
    v_mov_b32 v224, s51
    v_mov_b32 v225, 1
    s_mov_b64 exec, 1
    global_store_dword v224, v225, s[4:5] sc1
    s_mov_b64 exec, -1
P1_sigdone:
    s_setprio 3
    v_mov_b32 v209, v228
    v_mov_b32 v208, v229
    s_mov_b32 s10, s96
    s_and_b32 s11, s10, 1
    s_lshr_b32 s12, s10, 1
    s_lshr_b32 s20, s2, 2
    s_and_b32 s21, s2, 3
    s_lshl_b32 s26, s21, 3
    s_lshl_b32 s14, s11, 2
    s_add_u32 s26, s26, s14
    s_lshl_b32 s14, s20, 4
    s_lshr_b32 s15, s26, 1
    s_add_u32 s14, s14, s15
    s_mul_i32 s14, s14, 3072
    s_add_u32 s14, s14, 0
    s_lshl_b32 s15, s12, 16
    s_add_u32 s15, s15, 4194304
    s_add_u32 s8, s4, s14
    s_addc_u32 s9, s5, 0
    s_add_u32 s6, s4, s15
    s_addc_u32 s7, s5, 0
    s_add_u32 s24, s4, 4718592
    s_addc_u32 s25, s5, 0
    s_mov_b32 s16, -1
    s_mov_b32 s17, 0
    s_mov_b32 s18, 0
    s_mov_b32 s19, -1
    s_mov_b32 s22, 0x42700000
    s_cmp_lt_u32 s10, 4
    s_cselect_b32 s23, 1, 99
    v_mov_b32 v224, 0
    v_mov_b32 v225, 0
    v_mov_b32 v226, 0
    v_mov_b32 v227, 0
    v_mov_b32 v136, 0
    v_mov_b32 v137, 0
    v_mov_b32 v138, 0
    v_mov_b32 v139, 0
    v_mov_b32 v140, 0
    v_mov_b32 v141, 0
    v_mov_b32 v142, 0
    v_mov_b32 v143, 0
    v_mfma_f32_32x32x16_bf16 v[0:15], v[224:227], v[224:227], 0
    v_mfma_f32_32x32x16_bf16 v[16:31], v[224:227], v[224:227], 0
    v_mfma_f32_32x32x16_bf16 v[32:47], v[224:227], v[224:227], 0
    v_mfma_f32_32x32x16_bf16 v[48:63], v[224:227], v[224:227], 0
    v_mov_b32 v200, 0
    v_mov_b32 v201, 0
    v_mov_b32 v202, 0
    v_mov_b32 v203, 0
    v_mov_b32 v204, 0
    v_mov_b32 v205, 0
    v_mov_b32 v206, 0
    v_mov_b32 v207, 0
    s_mul_i32 s14, s11, 36864
    v_add_u32 v218, s14, v208
    s_mul_i32 s15, s12, 9216
    s_add_u32 s14, s14, s15
    v_add_u32 v219, s14, v208
    v_lshrrev_b32 v210, 5, v209
    v_and_b32 v211, 31, v209
    v_lshlrev_b32 v211, 4, v211
    s_lshl_b32 s44, s11, 2
    s_add_u32 s44, s44, s12
    s_mul_i32 s42, s44, 5
    s_lshr_b32 s14, s42, 2
    s_lshl_b32 s14, s14, 10
    s_bfe_u32 s43, s42, 0x10001
    s_lshl_b32 s43, s43, 9
    s_add_u32 s14, s14, s43
    s_and_b32 s43, s42, 1
    s_lshl_b32 s43, s43, 3
    s_add_u32 s14, s14, s43
    s_add_u32 s42, s42, 1
    s_lshr_b32 s15, s42, 2
    s_lshl_b32 s15, s15, 10
    s_bfe_u32 s43, s42, 0x10001
    s_lshl_b32 s43, s43, 9
    s_add_u32 s15, s15, s43
    s_and_b32 s43, s42, 1
    s_lshl_b32 s43, s43, 3
    s_add_u32 s15, s15, s43
    s_add_u32 s42, s42, 1
    s_sub_u32 s15, s15, s14
    s_add_u32 s14, s14, 122880
    v_add_u32 v215, s14, v211
    v_mad_u32_u24 v215, v210, s15, v215
    s_lshr_b32 s14, s42, 2
    s_lshl_b32 s14, s14, 10
    s_bfe_u32 s43, s42, 0x10001
    s_lshl_b32 s43, s43, 9
    s_add_u32 s14, s14, s43
    s_and_b32 s43, s42, 1
    s_lshl_b32 s43, s43, 3
    s_add_u32 s14, s14, s43
    s_add_u32 s42, s42, 1
    s_lshr_b32 s15, s42, 2
    s_lshl_b32 s15, s15, 10
    s_bfe_u32 s43, s42, 0x10001
    s_lshl_b32 s43, s43, 9
    s_add_u32 s15, s15, s43
    s_and_b32 s43, s42, 1
    s_lshl_b32 s43, s43, 3
    s_add_u32 s15, s15, s43
    s_add_u32 s42, s42, 1
    s_sub_u32 s15, s15, s14
    s_add_u32 s14, s14, 122880
    v_add_u32 v216, s14, v211
    v_mad_u32_u24 v216, v210, s15, v216
    s_lshr_b32 s14, s42, 2
    s_lshl_b32 s14, s14, 10
    s_bfe_u32 s43, s42, 0x10001
    s_lshl_b32 s43, s43, 9
    s_add_u32 s14, s14, s43
    s_and_b32 s43, s42, 1
    s_lshl_b32 s43, s43, 3
    s_add_u32 s14, s14, s43
    s_add_u32 s42, s42, 1
    s_lshr_b32 s15, s42, 2
    s_lshl_b32 s15, s15, 10
    s_bfe_u32 s43, s42, 0x10001
    s_lshl_b32 s43, s43, 9
    s_add_u32 s15, s15, s43
    s_and_b32 s43, s42, 1
    s_lshl_b32 s43, s43, 3
    s_add_u32 s15, s15, s43
    s_add_u32 s42, s42, 1
    s_sub_u32 s15, s15, s14
    s_add_u32 s14, s14, 122880
    v_add_u32 v217, s14, v211
    s_mul_i32 s42, s10, 5
    s_lshr_b32 s14, s42, 2
    s_lshl_b32 s14, s14, 10
    s_bfe_u32 s43, s42, 0x10001
    s_lshl_b32 s43, s43, 9
    s_add_u32 s14, s14, s43
    s_and_b32 s43, s42, 1
    s_lshl_b32 s43, s43, 3
    s_add_u32 s14, s14, s43
    s_add_u32 s42, s42, 1
    s_lshr_b32 s15, s42, 2
    s_lshl_b32 s15, s15, 10
    s_bfe_u32 s43, s42, 0x10001
    s_lshl_b32 s43, s43, 9
    s_add_u32 s15, s15, s43
    s_and_b32 s43, s42, 1
    s_lshl_b32 s43, s43, 3
    s_add_u32 s15, s15, s43
    s_add_u32 s42, s42, 1
    s_sub_u32 s15, s15, s14
    s_add_u32 s14, s14, 133120
    v_add_u32 v220, s14, v211
    v_mad_u32_u24 v220, v210, s15, v220
    s_lshr_b32 s14, s42, 2
    s_lshl_b32 s14, s14, 10
    s_bfe_u32 s43, s42, 0x10001
    s_lshl_b32 s43, s43, 9
    s_add_u32 s14, s14, s43
    s_and_b32 s43, s42, 1
    s_lshl_b32 s43, s43, 3
    s_add_u32 s14, s14, s43
    s_add_u32 s42, s42, 1
    s_lshr_b32 s15, s42, 2
    s_lshl_b32 s15, s15, 10
    s_bfe_u32 s43, s42, 0x10001
    s_lshl_b32 s43, s43, 9
    s_add_u32 s15, s15, s43
    s_and_b32 s43, s42, 1
    s_lshl_b32 s43, s43, 3
    s_add_u32 s15, s15, s43
    s_add_u32 s42, s42, 1
    s_sub_u32 s15, s15, s14
    s_add_u32 s14, s14, 133120
    v_add_u32 v221, s14, v211
    v_mad_u32_u24 v221, v210, s15, v221
    s_lshr_b32 s14, s42, 2
    s_lshl_b32 s14, s14, 10
    s_bfe_u32 s43, s42, 0x10001
    s_lshl_b32 s43, s43, 9
    s_add_u32 s14, s14, s43
    s_and_b32 s43, s42, 1
    s_lshl_b32 s43, s43, 3
    s_add_u32 s14, s14, s43
    s_add_u32 s42, s42, 1
    s_lshr_b32 s15, s42, 2
    s_lshl_b32 s15, s15, 10
    s_bfe_u32 s43, s42, 0x10001
    s_lshl_b32 s43, s43, 9
    s_add_u32 s15, s15, s43
    s_and_b32 s43, s42, 1
    s_lshl_b32 s43, s43, 3
    s_add_u32 s15, s15, s43
    s_add_u32 s42, s42, 1
    s_sub_u32 s15, s15, s14
    s_add_u32 s14, s14, 133120
    v_add_u32 v222, s14, v211
    s_lshl_b32 s14, s20, 4
    s_lshl_b32 s15, s21, 2
    s_add_u32 s14, s14, s15
    s_add_u32 s14, s14, s12
    s_mul_i32 s14, s14, 5120
    s_add_u32 s14, s14, 11534336
    s_add_u32 s38, s4, s14
    s_addc_u32 s39, s5, 0
    s_lshl_b32 s14, s21, 3
    s_add_u32 s14, s14, s10
    s_mul_i32 s15, s14, 2560
    s_add_u32 s15, s15, 20971520
    s_add_u32 s46, s4, s15
    s_addc_u32 s47, s5, 0
    s_lshl_b32 s48, s14, 7
    s_add_u32 s48, s48, 22025216
    s_mul_i32 s14, s20, 40
    s_mul_i32 s15, s21, 10
    s_add_u32 s14, s14, s15
    s_lshl_b32 s14, s14, 10
    s_add_u32 s14, s14, 5242880
    s_add_u32 s36, s4, s14
    s_addc_u32 s37, s5, 0
    s_lshr_b32 s14, s20, 2
    s_lshl_b32 s14, s14, 2
    s_add_u32 s14, s14, s21
    s_lshl_b32 s14, s14, 7
    s_add_u32 s15, s14, 22045696
    v_mov_b32 v213, s48
    v_mov_b32 v210, s15
    v_cmp_eq_u32 vcc, 1, v209
    s_nop 1
    v_cndmask_b32 v213, v213, v210, vcc
    v_lshlrev_b32 v211, 2, v209
    v_add_u32 v212, 3072, v208
    s_cmp_ge_u32 s10, 5
    s_cbranch_scc0 P2_nodrain
    s_waitcnt vmcnt(0)
P2_nodrain:
    s_cmp_eq_u32 s10, 4
    s_cbranch_scc0 P2_nopoll
    v_mov_b32 v233, 1
    s_waitcnt vmcnt(0)
    s_mov_b32 s60, 2000000
    s_branch G_pchk3
G_poll3:
    global_load_dword v234, v232, s[4:5] sc1
    s_waitcnt vmcnt(0)
G_pchk3:
    v_cmp_le_u32 vcc, v233, v234
    s_sub_u32 s60, s60, 1
    s_cmp_eq_u32 s60, 0
    s_cbranch_scc1 G_pend3
    s_cmp_eq_u64 vcc, -1
    s_cbranch_scc1 G_pend3
    s_sleep 8
    s_branch G_poll3
G_pend3:
P2_nopoll:
    s_barrier
    global_load_dword v214, v211, s[24:25] sc1
    global_load_dwordx4 v[88:91], v208, s[8:9] offset:2048 sc1
    global_load_dwordx4 v[64:67], v208, s[8:9] sc1
    global_load_dwordx4 v[68:71], v208, s[8:9] offset:1024 sc1
    global_load_dwordx4 v[92:95], v212, s[8:9] offset:2048 sc1
    global_load_dwordx4 v[72:75], v212, s[8:9] sc1
    global_load_dwordx4 v[76:79], v212, s[8:9] offset:1024 sc1
    global_load_dwordx4 v[144:147], v208, s[6:7] offset:0 sc1
    global_load_dwordx4 v[148:151], v208, s[6:7] offset:1024 sc1
    global_load_dwordx4 v[152:155], v208, s[6:7] offset:2048 sc1
    global_load_dwordx4 v[156:159], v208, s[6:7] offset:3072 sc1
    s_add_u32 s6, s6, 4096
    s_addc_u32 s7, s7, 0
    global_load_dwordx4 v[160:163], v208, s[6:7] offset:0 sc1
    global_load_dwordx4 v[164:167], v208, s[6:7] offset:1024 sc1
    global_load_dwordx4 v[168:171], v208, s[6:7] offset:2048 sc1
    global_load_dwordx4 v[172:175], v208, s[6:7] offset:3072 sc1
    s_add_u32 s6, s6, 4096
    s_addc_u32 s7, s7, 0
    global_load_dwordx4 v[176:179], v208, s[6:7] offset:0 sc1
    global_load_dwordx4 v[180:183], v208, s[6:7] offset:1024 sc1
    global_load_dwordx4 v[184:187], v208, s[6:7] offset:2048 sc1
    global_load_dwordx4 v[188:191], v208, s[6:7] offset:3072 sc1
    s_cmp_ge_u32 s50, 3
    s_cbranch_scc0 P2_nodefer
    s_cmp_eq_u32 s10, 5
    s_cbranch_scc1 P2_dsig
    s_cmp_lt_u32 s10, 4
    s_cbranch_scc0 P2_nodefer
    s_waitcnt vmcnt(19)
    v_mov_b32 v232, 157184
    v_mov_b32 v233, 1
    s_mov_b64 exec, 1
    ds_add_u32 v232, v233
    s_mov_b64 exec, -1
    s_branch P2_nodefer
P2_dsig:
    v_mov_b32 v232, 157184
    s_mov_b32 s60, 2000000
P2_dspin:
    ds_read_b32 v233, v232
    s_waitcnt lgkmcnt(0)
    v_readfirstlane_b32 s61, v233
    s_sub_u32 s60, s60, 1
    s_cmp_eq_u32 s60, 0
    s_cbranch_scc1 P2_dgo
    s_cmp_lt_u32 s61, 4
    s_cbranch_scc1 P2_dspin
P2_dgo:
    s_cmp_eq_u32 s50, 4
    s_cbranch_scc1 P2_dkv
    v_mov_b32 v232, s51
    v_mov_b32 v233, 1
    s_mov_b64 exec, 1
    global_store_dword v232, v233, s[4:5] sc1
    s_mov_b64 exec, -1
    s_branch P2_nodefer
P2_dkv:
    s_add_u32 s14, s51, 3072
    v_mov_b32 v232, s51
    v_mov_b32 v233, 1
    s_mov_b64 exec, 1
    global_atomic_add v233, v232, v233, s[4:5] sc0 sc1
    s_mov_b64 exec, -1
    s_waitcnt vmcnt(0)
    v_readfirstlane_b32 s60, v233
    s_cmp_eq_u32 s60, 15
    s_cbranch_scc0 G_nolast4
    v_lshlrev_b32 v232, 7, v228
    v_add_u32 v232, s14, v232
    v_mov_b32 v233, 1
    s_mov_b64 exec, 1
    global_store_dword v232, v233, s[4:5] sc1
    s_mov_b64 exec, -1
G_nolast4:
P2_nodefer:
    s_cmp_eq_u32 s10, 7
    s_cbranch_scc0 P2_nokr
    s_bfe_u32 s14, s2, 0x30002
    s_lshl_b32 s14, s14, 7
    s_add_u32 s14, s14, 22024192
    v_mov_b32 v232, s14
    v_mov_b32 v233, 1
    s_mov_b32 s60, 2000000
G_poll5:
    global_load_dword v234, v232, s[4:5] sc1
    s_waitcnt vmcnt(0)
G_pchk5:
    v_cmp_le_u32 vcc, v233, v234
    s_sub_u32 s60, s60, 1
    s_cmp_eq_u32 s60, 0
    s_cbranch_scc1 G_pend5
    s_cmp_eq_u64 vcc, -1
    s_cbranch_scc1 G_pend5
    s_sleep 8
    s_branch G_poll5
G_pend5:
    s_and_b32 s14, s2, 31
    s_mul_i32 s14, s14, 5120
    s_add_u32 s14, s14, 17825792
    s_add_u32 s32, s4, s14
    s_addc_u32 s33, s5, 0
    s_lshr_b32 s14, s2, 5
    s_lshl_b32 s14, s14, 3
    v_and_b32 v232, 7, v209
    v_add_u32 v232, s14, v232
    v_lshrrev_b32 v233, 3, v209
    v_lshlrev_b32 v234, 10, v233
    v_lshl_add_u32 v234, v232, 4, v234
    s_mov_b32 exec_lo, -1
    s_mov_b32 exec_hi, 0xff
    global_load_dwordx4 v[0:3], v234, s[32:33] sc1
    s_add_u32 s32, s32, 163840
    s_addc_u32 s33, s33, 0
    global_load_dwordx4 v[4:7], v234, s[32:33] sc1
    s_add_u32 s32, s32, 163840
    s_addc_u32 s33, s33, 0
    global_load_dwordx4 v[8:11], v234, s[32:33] sc1
    s_add_u32 s32, s32, 163840
    s_addc_u32 s33, s33, 0
    global_load_dwordx4 v[12:15], v234, s[32:33] sc1
    s_add_u32 s32, s32, 163840
    s_addc_u32 s33, s33, 0
    global_load_dwordx4 v[16:19], v234, s[32:33] sc1
    s_add_u32 s32, s32, 163840
    s_addc_u32 s33, s33, 0
    global_load_dwordx4 v[20:23], v234, s[32:33] sc1
    s_add_u32 s32, s32, 163840
    s_addc_u32 s33, s33, 0
    global_load_dwordx4 v[24:27], v234, s[32:33] sc1
    s_add_u32 s32, s32, 163840
    s_addc_u32 s33, s33, 0
    global_load_dwordx4 v[28:31], v234, s[32:33] sc1
    s_add_u32 s32, s32, 163840
    s_addc_u32 s33, s33, 0
    global_load_dwordx4 v[32:35], v234, s[32:33] sc1
    s_add_u32 s32, s32, 163840
    s_addc_u32 s33, s33, 0
    global_load_dwordx4 v[36:39], v234, s[32:33] sc1
    s_add_u32 s32, s32, 163840
    s_addc_u32 s33, s33, 0
    global_load_dwordx4 v[40:43], v234, s[32:33] sc1
    s_add_u32 s32, s32, 163840
    s_addc_u32 s33, s33, 0
    global_load_dwordx4 v[44:47], v234, s[32:33] sc1
    s_add_u32 s32, s32, 163840
    s_addc_u32 s33, s33, 0
    global_load_dwordx4 v[48:51], v234, s[32:33] sc1
    s_add_u32 s32, s32, 163840
    s_addc_u32 s33, s33, 0
    global_load_dwordx4 v[52:55], v234, s[32:33] sc1
    s_add_u32 s32, s32, 163840
    s_addc_u32 s33, s33, 0
    global_load_dwordx4 v[56:59], v234, s[32:33] sc1
    s_add_u32 s32, s32, 163840
    s_addc_u32 s33, s33, 0
    global_load_dwordx4 v[60:63], v234, s[32:33] sc1
    s_mov_b64 exec, -1
    v_and_b32 v235, 1, v233
    v_lshlrev_b32 v235, 3, v235
    v_lshl_add_u32 v235, v232, 4, v235
    v_lshrrev_b32 v236, 1, v233
    v_lshl_add_u32 v235, v236, 10, v235
    v_lshlrev_b32 v236, 3, v232
    v_add_u32 v236, 2048, v236
    v_cmp_eq_u32 vcc, 4, v233
    s_nop 1
    v_cndmask_b32 v235, v235, v236, vcc
    s_waitcnt vmcnt(0)
    v_pk_add_f32 v[0:1], v[0:1], v[32:33]
    v_pk_add_f32 v[2:3], v[2:3], v[34:35]
    v_pk_add_f32 v[4:5], v[4:5], v[36:37]
    v_pk_add_f32 v[6:7], v[6:7], v[38:39]
    v_pk_add_f32 v[8:9], v[8:9], v[40:41]
    v_pk_add_f32 v[10:11], v[10:11], v[42:43]
    v_pk_add_f32 v[12:13], v[12:13], v[44:45]
    v_pk_add_f32 v[14:15], v[14:15], v[46:47]
    v_pk_add_f32 v[16:17], v[16:17], v[48:49]
    v_pk_add_f32 v[18:19], v[18:19], v[50:51]
    v_pk_add_f32 v[20:21], v[20:21], v[52:53]
    v_pk_add_f32 v[22:23], v[22:23], v[54:55]
    v_pk_add_f32 v[24:25], v[24:25], v[56:57]
    v_pk_add_f32 v[26:27], v[26:27], v[58:59]
    v_pk_add_f32 v[28:29], v[28:29], v[60:61]
    v_pk_add_f32 v[30:31], v[30:31], v[62:63]
    v_pk_add_f32 v[0:1], v[0:1], v[16:17]
    v_pk_add_f32 v[2:3], v[2:3], v[18:19]
    v_pk_add_f32 v[4:5], v[4:5], v[20:21]
    v_pk_add_f32 v[6:7], v[6:7], v[22:23]
    v_pk_add_f32 v[8:9], v[8:9], v[24:25]
    v_pk_add_f32 v[10:11], v[10:11], v[26:27]
    v_pk_add_f32 v[12:13], v[12:13], v[28:29]
    v_pk_add_f32 v[14:15], v[14:15], v[30:31]
    v_pk_add_f32 v[0:1], v[0:1], v[8:9]
    v_pk_add_f32 v[2:3], v[2:3], v[10:11]
    v_pk_add_f32 v[4:5], v[4:5], v[12:13]
    v_pk_add_f32 v[6:7], v[6:7], v[14:15]
    v_pk_add_f32 v[0:1], v[0:1], v[4:5]
    v_pk_add_f32 v[2:3], v[2:3], v[6:7]
    v_cvt_pk_bf16_f32 v236, v0, v1
    v_cvt_pk_bf16_f32 v237, v2, v3
    s_and_b32 s14, s2, 31
    s_mul_i32 s15, s14, 2560
    s_add_u32 s15, s15, 20971520
    v_add_u32 v235, s15, v235
    v_mfma_f32_32x32x16_bf16 v[0:15], v[224:227], v[224:227], 0
    v_mfma_f32_32x32x16_bf16 v[16:31], v[224:227], v[224:227], 0
    v_mfma_f32_32x32x16_bf16 v[32:47], v[224:227], v[224:227], 0
    v_mfma_f32_32x32x16_bf16 v[48:63], v[224:227], v[224:227], 0
    s_mov_b32 exec_lo, -1
    s_mov_b32 exec_hi, 0xff
    global_store_dwordx2 v235, v[236:237], s[4:5] sc1
    s_mov_b64 exec, -1
    s_lshl_b32 s14, s14, 7
    s_add_u32 s14, s14, 22025216
    s_waitcnt vmcnt(0)
    v_mov_b32 v232, s14
    v_mov_b32 v233, 1
    s_mov_b64 exec, 1
    global_atomic_add v232, v233, s[4:5] sc1
    s_mov_b64 exec, -1
P2_nokr:
    s_waitcnt vmcnt(18)
    v_max_f32_dpp v214, v214, v214 row_ror:8 row_mask:0xf bank_mask:0xf
    s_nop 1
    v_max_f32_dpp v214, v214, v214 row_ror:4 row_mask:0xf bank_mask:0xf
    s_nop 1
    v_max_f32_dpp v214, v214, v214 row_ror:2 row_mask:0xf bank_mask:0xf
    s_nop 1
    v_max_f32_dpp v214, v214, v214 row_ror:1 row_mask:0xf bank_mask:0xf
    s_nop 0
    v_readlane_b32 s42, v214, 0
    v_readlane_b32 s15, v214, 16
    v_readlane_b32 s30, v214, 32
    v_readlane_b32 s31, v214, 48
    s_max_u32 s42, s42, s15
    s_max_u32 s30, s30, s31
    s_max_u32 s42, s42, s30
    v_sqrt_f32 v214, s42
    s_nop 0
    v_mul_f32 v214, 0x3f828f5c, v214
    s_waitcnt vmcnt(14)
    v_fma_f32 v91, -v90, v214, s22
    v_fma_f32 v95, -v94, v214, s22
    v_cvt_pk_bf16_f32 v91, v91, 0
    v_cvt_pk_bf16_f32 v95, v95, 0
    v_cndmask_b32 v80, v91, v88, s[16:17]
    v_cndmask_b32 v81, 0, v89, s[16:17]
    v_cndmask_b32 v82, v91, v88, s[18:19]
    v_cndmask_b32 v83, 0, v89, s[18:19]
    v_cndmask_b32 v84, v95, v92, s[16:17]
    v_cndmask_b32 v85, 0, v93, s[16:17]
    v_cndmask_b32 v86, v95, v92, s[18:19]
    v_cndmask_b32 v87, 0, v93, s[18:19]
    s_waitcnt vmcnt(8)
    v_mfma_f32_32x32x16_bf16 v[96:111], v[144:147], v[64:67], 0
    v_mfma_f32_32x32x8_bf16 v[96:111], v[148:149], v[80:81], v[96:111]
    s_mov_b32 s13, 4
    s_cmp_lt_u32 s10, 4
    s_cbranch_scc1 P2_p2
    s_setprio 1
    s_branch P2_p3
P2_p2:
    s_setprio 2
P2_p3:
    s_nop 7
    s_nop 7
.p2align 6
P2_loop:
    v_mfma_f32_32x32x16_bf16 v[112:127], v[144:147], v[68:71], 0
    v_exp_f32 v96, v96
    v_exp_f32 v97, v97
    v_exp_f32 v98, v98
    v_exp_f32 v99, v99
    v_cvt_pk_bf16_f32 v128, v96, v97
    v_cvt_pk_bf16_f32 v129, v98, v99
    v_mfma_f32_32x32x8_bf16 v[112:127], v[150:151], v[82:83], v[112:127]
    v_exp_f32 v100, v100
    v_exp_f32 v101, v101
    v_exp_f32 v102, v102
    v_exp_f32 v103, v103
    v_cvt_pk_bf16_f32 v130, v100, v101
    v_cvt_pk_bf16_f32 v131, v102, v103
    v_mfma_f32_32x32x16_bf16 v[48:63], v[200:203], v[136:139], v[48:63]
    v_exp_f32 v104, v104
    v_exp_f32 v105, v105
    v_exp_f32 v106, v106
    v_exp_f32 v107, v107
    v_cvt_pk_bf16_f32 v132, v104, v105
    v_cvt_pk_bf16_f32 v133, v106, v107
    v_mfma_f32_32x32x16_bf16 v[48:63], v[204:207], v[140:143], v[48:63]
    v_exp_f32 v108, v108
    v_exp_f32 v109, v109
    v_exp_f32 v110, v110
    v_exp_f32 v111, v111
    v_cvt_pk_bf16_f32 v134, v108, v109
    v_cvt_pk_bf16_f32 v135, v110, v111
    v_mfma_f32_32x32x16_bf16 v[96:111], v[144:147], v[72:75], 0
    v_exp_f32 v112, v112
    v_exp_f32 v113, v113
    v_exp_f32 v114, v114
    v_exp_f32 v115, v115
    v_cvt_pk_bf16_f32 v136, v112, v113
    v_cvt_pk_bf16_f32 v137, v114, v115
    v_mfma_f32_32x32x8_bf16 v[96:111], v[148:149], v[84:85], v[96:111]
    v_exp_f32 v116, v116
    v_exp_f32 v117, v117
    v_exp_f32 v118, v118
    v_exp_f32 v119, v119
    v_cvt_pk_bf16_f32 v138, v116, v117
    v_cvt_pk_bf16_f32 v139, v118, v119
    v_mfma_f32_32x32x16_bf16 v[0:15], v[152:155], v[128:131], v[0:15]
    v_exp_f32 v120, v120
    v_exp_f32 v121, v121
    v_exp_f32 v122, v122
    v_exp_f32 v123, v123
    v_cvt_pk_bf16_f32 v140, v120, v121
    v_cvt_pk_bf16_f32 v141, v122, v123
    v_mfma_f32_32x32x16_bf16 v[0:15], v[156:159], v[132:135], v[0:15]
    v_exp_f32 v124, v124
    v_exp_f32 v125, v125
    v_exp_f32 v126, v126
    v_exp_f32 v127, v127
    v_cvt_pk_bf16_f32 v142, v124, v125
    v_cvt_pk_bf16_f32 v143, v126, v127
    v_mfma_f32_32x32x16_bf16 v[112:127], v[144:147], v[76:79], 0
    v_exp_f32 v96, v96
    v_exp_f32 v97, v97
    v_exp_f32 v98, v98
    v_exp_f32 v99, v99
    v_cvt_pk_bf16_f32 v128, v96, v97
    v_cvt_pk_bf16_f32 v129, v98, v99
    v_mfma_f32_32x32x8_bf16 v[112:127], v[150:151], v[86:87], v[112:127]
    v_exp_f32 v100, v100
    v_exp_f32 v101, v101
    v_exp_f32 v102, v102
    v_exp_f32 v103, v103
    v_cvt_pk_bf16_f32 v130, v100, v101
    v_cvt_pk_bf16_f32 v131, v102, v103
    v_mfma_f32_32x32x16_bf16 v[16:31], v[152:155], v[136:139], v[16:31]
    v_exp_f32 v104, v104
    v_exp_f32 v105, v105
    v_exp_f32 v106, v106
    v_exp_f32 v107, v107
    v_cvt_pk_bf16_f32 v132, v104, v105
    v_cvt_pk_bf16_f32 v133, v106, v107
    v_mfma_f32_32x32x16_bf16 v[16:31], v[156:159], v[140:143], v[16:31]
    v_exp_f32 v108, v108
    v_exp_f32 v109, v109
    v_exp_f32 v110, v110
    v_exp_f32 v111, v111
    v_cvt_pk_bf16_f32 v134, v108, v109
    v_cvt_pk_bf16_f32 v135, v110, v111
    s_waitcnt vmcnt(4)
    s_add_u32 s6, s6, 4096
    s_addc_u32 s7, s7, 0
    s_cmp_eq_u32 s13, 1
    s_cbranch_scc0 P2_norc
    global_load_dword v223, v213, s[4:5] sc1
P2_norc:
    global_load_dwordx4 v[192:195], v208, s[6:7] offset:0 sc1
    global_load_dwordx4 v[196:199], v208, s[6:7] offset:1024 sc1
    global_load_dwordx4 v[200:203], v208, s[6:7] offset:2048 sc1
    global_load_dwordx4 v[204:207], v208, s[6:7] offset:3072 sc1
    v_mfma_f32_32x32x16_bf16 v[96:111], v[160:163], v[64:67], 0
    v_exp_f32 v112, v112
    v_exp_f32 v113, v113
    v_exp_f32 v114, v114
    v_exp_f32 v115, v115
    v_cvt_pk_bf16_f32 v136, v112, v113
    v_cvt_pk_bf16_f32 v137, v114, v115
    v_mfma_f32_32x32x8_bf16 v[96:111], v[164:165], v[80:81], v[96:111]
    v_exp_f32 v116, v116
    v_exp_f32 v117, v117
    v_exp_f32 v118, v118
    v_exp_f32 v119, v119
    v_cvt_pk_bf16_f32 v138, v116, v117
    v_cvt_pk_bf16_f32 v139, v118, v119
    v_mfma_f32_32x32x16_bf16 v[32:47], v[152:155], v[128:131], v[32:47]
    v_exp_f32 v120, v120
    v_exp_f32 v121, v121
    v_exp_f32 v122, v122
    v_exp_f32 v123, v123
    v_cvt_pk_bf16_f32 v140, v120, v121
    v_cvt_pk_bf16_f32 v141, v122, v123
    v_mfma_f32_32x32x16_bf16 v[32:47], v[156:159], v[132:135], v[32:47]
    v_exp_f32 v124, v124
    v_exp_f32 v125, v125
    v_exp_f32 v126, v126
    v_exp_f32 v127, v127
    v_cvt_pk_bf16_f32 v142, v124, v125
    v_cvt_pk_bf16_f32 v143, v126, v127
    v_mfma_f32_32x32x16_bf16 v[112:127], v[160:163], v[68:71], 0
    v_exp_f32 v96, v96
    v_exp_f32 v97, v97
    v_exp_f32 v98, v98
    v_exp_f32 v99, v99
    v_cvt_pk_bf16_f32 v128, v96, v97
    v_cvt_pk_bf16_f32 v129, v98, v99
    v_mfma_f32_32x32x8_bf16 v[112:127], v[166:167], v[82:83], v[112:127]
    v_exp_f32 v100, v100
    v_exp_f32 v101, v101
    v_exp_f32 v102, v102
    v_exp_f32 v103, v103
    v_cvt_pk_bf16_f32 v130, v100, v101
    v_cvt_pk_bf16_f32 v131, v102, v103
    v_mfma_f32_32x32x16_bf16 v[48:63], v[152:155], v[136:139], v[48:63]
    v_exp_f32 v104, v104
    v_exp_f32 v105, v105
    v_exp_f32 v106, v106
    v_exp_f32 v107, v107
    v_cvt_pk_bf16_f32 v132, v104, v105
    v_cvt_pk_bf16_f32 v133, v106, v107
    v_mfma_f32_32x32x16_bf16 v[48:63], v[156:159], v[140:143], v[48:63]
    v_exp_f32 v108, v108
    v_exp_f32 v109, v109
    v_exp_f32 v110, v110
    v_exp_f32 v111, v111
    v_cvt_pk_bf16_f32 v134, v108, v109
    v_cvt_pk_bf16_f32 v135, v110, v111
    v_mfma_f32_32x32x16_bf16 v[96:111], v[160:163], v[72:75], 0
    v_exp_f32 v112, v112
    v_exp_f32 v113, v113
    v_exp_f32 v114, v114
    v_exp_f32 v115, v115
    v_cvt_pk_bf16_f32 v136, v112, v113
    v_cvt_pk_bf16_f32 v137, v114, v115
    v_mfma_f32_32x32x8_bf16 v[96:111], v[164:165], v[84:85], v[96:111]
    v_exp_f32 v116, v116
    v_exp_f32 v117, v117
    v_exp_f32 v118, v118
    v_exp_f32 v119, v119
    v_cvt_pk_bf16_f32 v138, v116, v117
    v_cvt_pk_bf16_f32 v139, v118, v119
    v_mfma_f32_32x32x16_bf16 v[0:15], v[168:171], v[128:131], v[0:15]
    v_exp_f32 v120, v120
    v_exp_f32 v121, v121
    v_exp_f32 v122, v122
    v_exp_f32 v123, v123
    v_cvt_pk_bf16_f32 v140, v120, v121
    v_cvt_pk_bf16_f32 v141, v122, v123
    v_mfma_f32_32x32x16_bf16 v[0:15], v[172:175], v[132:135], v[0:15]
    v_exp_f32 v124, v124
    v_exp_f32 v125, v125
    v_exp_f32 v126, v126
    v_exp_f32 v127, v127
    v_cvt_pk_bf16_f32 v142, v124, v125
    v_cvt_pk_bf16_f32 v143, v126, v127
    v_mfma_f32_32x32x16_bf16 v[112:127], v[160:163], v[76:79], 0
    v_exp_f32 v96, v96
    v_exp_f32 v97, v97
    v_exp_f32 v98, v98
    v_exp_f32 v99, v99
    v_cvt_pk_bf16_f32 v128, v96, v97
    v_cvt_pk_bf16_f32 v129, v98, v99
    v_mfma_f32_32x32x8_bf16 v[112:127], v[166:167], v[86:87], v[112:127]
    v_exp_f32 v100, v100
    v_exp_f32 v101, v101
    v_exp_f32 v102, v102
    v_exp_f32 v103, v103
    v_cvt_pk_bf16_f32 v130, v100, v101
    v_cvt_pk_bf16_f32 v131, v102, v103
    v_mfma_f32_32x32x16_bf16 v[16:31], v[168:171], v[136:139], v[16:31]
    v_exp_f32 v104, v104
    v_exp_f32 v105, v105
    v_exp_f32 v106, v106
    v_exp_f32 v107, v107
    v_cvt_pk_bf16_f32 v132, v104, v105
    v_cvt_pk_bf16_f32 v133, v106, v107
    v_mfma_f32_32x32x16_bf16 v[16:31], v[172:175], v[140:143], v[16:31]
    v_exp_f32 v108, v108
    v_exp_f32 v109, v109
    v_exp_f32 v110, v110
    v_exp_f32 v111, v111
    v_cvt_pk_bf16_f32 v134, v108, v109
    v_cvt_pk_bf16_f32 v135, v110, v111
    s_waitcnt vmcnt(4)
    s_add_u32 s6, s6, 4096
    s_addc_u32 s7, s7, 0
    s_cmp_eq_u32 s13, s23
    s_cbranch_scc0 P2_noyield
    s_setprio 0
P2_noyield:
    global_load_dwordx4 v[144:147], v208, s[6:7] offset:0 sc1
    global_load_dwordx4 v[148:151], v208, s[6:7] offset:1024 sc1
    global_load_dwordx4 v[152:155], v208, s[6:7] offset:2048 sc1
    global_load_dwordx4 v[156:159], v208, s[6:7] offset:3072 sc1
    v_mfma_f32_32x32x16_bf16 v[96:111], v[176:179], v[64:67], 0
    v_exp_f32 v112, v112
    v_exp_f32 v113, v113
    v_exp_f32 v114, v114
    v_exp_f32 v115, v115
    v_cvt_pk_bf16_f32 v136, v112, v113
    v_cvt_pk_bf16_f32 v137, v114, v115
    v_mfma_f32_32x32x8_bf16 v[96:111], v[180:181], v[80:81], v[96:111]
    v_exp_f32 v116, v116
    v_exp_f32 v117, v117
    v_exp_f32 v118, v118
    v_exp_f32 v119, v119
    v_cvt_pk_bf16_f32 v138, v116, v117
    v_cvt_pk_bf16_f32 v139, v118, v119
    v_mfma_f32_32x32x16_bf16 v[32:47], v[168:171], v[128:131], v[32:47]
    v_exp_f32 v120, v120
    v_exp_f32 v121, v121
    v_exp_f32 v122, v122
    v_exp_f32 v123, v123
    v_cvt_pk_bf16_f32 v140, v120, v121
    v_cvt_pk_bf16_f32 v141, v122, v123
    v_mfma_f32_32x32x16_bf16 v[32:47], v[172:175], v[132:135], v[32:47]
    v_exp_f32 v124, v124
    v_exp_f32 v125, v125
    v_exp_f32 v126, v126
    v_exp_f32 v127, v127
    v_cvt_pk_bf16_f32 v142, v124, v125
    v_cvt_pk_bf16_f32 v143, v126, v127
    v_mfma_f32_32x32x16_bf16 v[112:127], v[176:179], v[68:71], 0
    v_exp_f32 v96, v96
    v_exp_f32 v97, v97
    v_exp_f32 v98, v98
    v_exp_f32 v99, v99
    v_cvt_pk_bf16_f32 v128, v96, v97
    v_cvt_pk_bf16_f32 v129, v98, v99
    v_mfma_f32_32x32x8_bf16 v[112:127], v[182:183], v[82:83], v[112:127]
    v_exp_f32 v100, v100
    v_exp_f32 v101, v101
    v_exp_f32 v102, v102
    v_exp_f32 v103, v103
    v_cvt_pk_bf16_f32 v130, v100, v101
    v_cvt_pk_bf16_f32 v131, v102, v103
    v_mfma_f32_32x32x16_bf16 v[48:63], v[168:171], v[136:139], v[48:63]
    v_exp_f32 v104, v104
    v_exp_f32 v105, v105
    v_exp_f32 v106, v106
    v_exp_f32 v107, v107
    v_cvt_pk_bf16_f32 v132, v104, v105
    v_cvt_pk_bf16_f32 v133, v106, v107
    v_mfma_f32_32x32x16_bf16 v[48:63], v[172:175], v[140:143], v[48:63]
    v_exp_f32 v108, v108
    v_exp_f32 v109, v109
    v_exp_f32 v110, v110
    v_exp_f32 v111, v111
    v_cvt_pk_bf16_f32 v134, v108, v109
    v_cvt_pk_bf16_f32 v135, v110, v111
    v_mfma_f32_32x32x16_bf16 v[96:111], v[176:179], v[72:75], 0
    v_exp_f32 v112, v112
    v_exp_f32 v113, v113
    v_exp_f32 v114, v114
    v_exp_f32 v115, v115
    v_cvt_pk_bf16_f32 v136, v112, v113
    v_cvt_pk_bf16_f32 v137, v114, v115
    v_mfma_f32_32x32x8_bf16 v[96:111], v[180:181], v[84:85], v[96:111]
    v_exp_f32 v116, v116
    v_exp_f32 v117, v117
    v_exp_f32 v118, v118
    v_exp_f32 v119, v119
    v_cvt_pk_bf16_f32 v138, v116, v117
    v_cvt_pk_bf16_f32 v139, v118, v119
    v_mfma_f32_32x32x16_bf16 v[0:15], v[184:187], v[128:131], v[0:15]
    v_exp_f32 v120, v120
    v_exp_f32 v121, v121
    v_exp_f32 v122, v122
    v_exp_f32 v123, v123
    v_cvt_pk_bf16_f32 v140, v120, v121
    v_cvt_pk_bf16_f32 v141, v122, v123
    v_mfma_f32_32x32x16_bf16 v[0:15], v[188:191], v[132:135], v[0:15]
    v_exp_f32 v124, v124
    v_exp_f32 v125, v125
    v_exp_f32 v126, v126
    v_exp_f32 v127, v127
    v_cvt_pk_bf16_f32 v142, v124, v125
    v_cvt_pk_bf16_f32 v143, v126, v127
    v_mfma_f32_32x32x16_bf16 v[112:127], v[176:179], v[76:79], 0
    v_exp_f32 v96, v96
    v_exp_f32 v97, v97
    v_exp_f32 v98, v98
    v_exp_f32 v99, v99
    v_cvt_pk_bf16_f32 v128, v96, v97
    v_cvt_pk_bf16_f32 v129, v98, v99
    v_mfma_f32_32x32x8_bf16 v[112:127], v[182:183], v[86:87], v[112:127]
    v_exp_f32 v100, v100
    v_exp_f32 v101, v101
    v_exp_f32 v102, v102
    v_exp_f32 v103, v103
    v_cvt_pk_bf16_f32 v130, v100, v101
    v_cvt_pk_bf16_f32 v131, v102, v103
    v_mfma_f32_32x32x16_bf16 v[16:31], v[184:187], v[136:139], v[16:31]
    v_exp_f32 v104, v104
    v_exp_f32 v105, v105
    v_exp_f32 v106, v106
    v_exp_f32 v107, v107
    v_cvt_pk_bf16_f32 v132, v104, v105
    v_cvt_pk_bf16_f32 v133, v106, v107
    v_mfma_f32_32x32x16_bf16 v[16:31], v[188:191], v[140:143], v[16:31]
    v_exp_f32 v108, v108
    v_exp_f32 v109, v109
    v_exp_f32 v110, v110
    v_exp_f32 v111, v111
    v_cvt_pk_bf16_f32 v134, v108, v109
    v_cvt_pk_bf16_f32 v135, v110, v111
    s_waitcnt vmcnt(4)
    s_add_u32 s6, s6, 4096
    s_addc_u32 s7, s7, 0
    global_load_dwordx4 v[160:163], v208, s[6:7] offset:0 sc1
    global_load_dwordx4 v[164:167], v208, s[6:7] offset:1024 sc1
    global_load_dwordx4 v[168:171], v208, s[6:7] offset:2048 sc1
    global_load_dwordx4 v[172:175], v208, s[6:7] offset:3072 sc1
    v_mfma_f32_32x32x16_bf16 v[96:111], v[192:195], v[64:67], 0
    v_exp_f32 v112, v112
    v_exp_f32 v113, v113
    v_exp_f32 v114, v114
    v_exp_f32 v115, v115
    v_cvt_pk_bf16_f32 v136, v112, v113
    v_cvt_pk_bf16_f32 v137, v114, v115
    v_mfma_f32_32x32x8_bf16 v[96:111], v[196:197], v[80:81], v[96:111]
    v_exp_f32 v116, v116
    v_exp_f32 v117, v117
    v_exp_f32 v118, v118
    v_exp_f32 v119, v119
    v_cvt_pk_bf16_f32 v138, v116, v117
    v_cvt_pk_bf16_f32 v139, v118, v119
    v_mfma_f32_32x32x16_bf16 v[32:47], v[184:187], v[128:131], v[32:47]
    v_exp_f32 v120, v120
    v_exp_f32 v121, v121
    v_exp_f32 v122, v122
    v_exp_f32 v123, v123
    v_cvt_pk_bf16_f32 v140, v120, v121
    v_cvt_pk_bf16_f32 v141, v122, v123
    v_mfma_f32_32x32x16_bf16 v[32:47], v[188:191], v[132:135], v[32:47]
    v_exp_f32 v124, v124
    v_exp_f32 v125, v125
    v_exp_f32 v126, v126
    v_exp_f32 v127, v127
    v_cvt_pk_bf16_f32 v142, v124, v125
    v_cvt_pk_bf16_f32 v143, v126, v127
    v_mfma_f32_32x32x16_bf16 v[112:127], v[192:195], v[68:71], 0
    v_exp_f32 v96, v96
    v_exp_f32 v97, v97
    v_exp_f32 v98, v98
    v_exp_f32 v99, v99
    v_cvt_pk_bf16_f32 v128, v96, v97
    v_cvt_pk_bf16_f32 v129, v98, v99
    v_mfma_f32_32x32x8_bf16 v[112:127], v[198:199], v[82:83], v[112:127]
    v_exp_f32 v100, v100
    v_exp_f32 v101, v101
    v_exp_f32 v102, v102
    v_exp_f32 v103, v103
    v_cvt_pk_bf16_f32 v130, v100, v101
    v_cvt_pk_bf16_f32 v131, v102, v103
    v_mfma_f32_32x32x16_bf16 v[48:63], v[184:187], v[136:139], v[48:63]
    v_exp_f32 v104, v104
    v_exp_f32 v105, v105
    v_exp_f32 v106, v106
    v_exp_f32 v107, v107
    v_cvt_pk_bf16_f32 v132, v104, v105
    v_cvt_pk_bf16_f32 v133, v106, v107
    v_mfma_f32_32x32x16_bf16 v[48:63], v[188:191], v[140:143], v[48:63]
    v_exp_f32 v108, v108
    v_exp_f32 v109, v109
    v_exp_f32 v110, v110
    v_exp_f32 v111, v111
    v_cvt_pk_bf16_f32 v134, v108, v109
    v_cvt_pk_bf16_f32 v135, v110, v111
    v_mfma_f32_32x32x16_bf16 v[96:111], v[192:195], v[72:75], 0
    v_exp_f32 v112, v112
    v_exp_f32 v113, v113
    v_exp_f32 v114, v114
    v_exp_f32 v115, v115
    v_cvt_pk_bf16_f32 v136, v112, v113
    v_cvt_pk_bf16_f32 v137, v114, v115
    v_mfma_f32_32x32x8_bf16 v[96:111], v[196:197], v[84:85], v[96:111]
    v_exp_f32 v116, v116
    v_exp_f32 v117, v117
    v_exp_f32 v118, v118
    v_exp_f32 v119, v119
    v_cvt_pk_bf16_f32 v138, v116, v117
    v_cvt_pk_bf16_f32 v139, v118, v119
    v_mfma_f32_32x32x16_bf16 v[0:15], v[200:203], v[128:131], v[0:15]
    v_exp_f32 v120, v120
    v_exp_f32 v121, v121
    v_exp_f32 v122, v122
    v_exp_f32 v123, v123
    v_cvt_pk_bf16_f32 v140, v120, v121
    v_cvt_pk_bf16_f32 v141, v122, v123
    v_mfma_f32_32x32x16_bf16 v[0:15], v[204:207], v[132:135], v[0:15]
    v_exp_f32 v124, v124
    v_exp_f32 v125, v125
    v_exp_f32 v126, v126
    v_exp_f32 v127, v127
    v_cvt_pk_bf16_f32 v142, v124, v125
    v_cvt_pk_bf16_f32 v143, v126, v127
    v_mfma_f32_32x32x16_bf16 v[112:127], v[192:195], v[76:79], 0
    v_exp_f32 v96, v96
    v_exp_f32 v97, v97
    v_exp_f32 v98, v98
    v_exp_f32 v99, v99
    v_cvt_pk_bf16_f32 v128, v96, v97
    v_cvt_pk_bf16_f32 v129, v98, v99
    v_mfma_f32_32x32x8_bf16 v[112:127], v[198:199], v[86:87], v[112:127]
    v_exp_f32 v100, v100
    v_exp_f32 v101, v101
    v_exp_f32 v102, v102
    v_exp_f32 v103, v103
    v_cvt_pk_bf16_f32 v130, v100, v101
    v_cvt_pk_bf16_f32 v131, v102, v103
    v_mfma_f32_32x32x16_bf16 v[16:31], v[200:203], v[136:139], v[16:31]
    v_exp_f32 v104, v104
    v_exp_f32 v105, v105
    v_exp_f32 v106, v106
    v_exp_f32 v107, v107
    v_cvt_pk_bf16_f32 v132, v104, v105
    v_cvt_pk_bf16_f32 v133, v106, v107
    v_mfma_f32_32x32x16_bf16 v[16:31], v[204:207], v[140:143], v[16:31]
    v_exp_f32 v108, v108
    v_exp_f32 v109, v109
    v_exp_f32 v110, v110
    v_exp_f32 v111, v111
    v_cvt_pk_bf16_f32 v134, v108, v109
    v_cvt_pk_bf16_f32 v135, v110, v111
    s_waitcnt vmcnt(4)
    s_add_u32 s6, s6, 4096
    s_addc_u32 s7, s7, 0
    s_sub_u32 s13, s13, 1
    s_cmp_lg_u32 s13, 0
    global_load_dwordx4 v[176:179], v208, s[6:7] offset:0 sc1
    global_load_dwordx4 v[180:183], v208, s[6:7] offset:1024 sc1
    global_load_dwordx4 v[184:187], v208, s[6:7] offset:2048 sc1
    global_load_dwordx4 v[188:191], v208, s[6:7] offset:3072 sc1
    v_mfma_f32_32x32x16_bf16 v[96:111], v[144:147], v[64:67], 0
    v_exp_f32 v112, v112
    v_exp_f32 v113, v113
    v_exp_f32 v114, v114
    v_exp_f32 v115, v115
    v_cvt_pk_bf16_f32 v136, v112, v113
    v_cvt_pk_bf16_f32 v137, v114, v115
    v_mfma_f32_32x32x8_bf16 v[96:111], v[148:149], v[80:81], v[96:111]
    v_exp_f32 v116, v116
    v_exp_f32 v117, v117
    v_exp_f32 v118, v118
    v_exp_f32 v119, v119
    v_cvt_pk_bf16_f32 v138, v116, v117
    v_cvt_pk_bf16_f32 v139, v118, v119
    v_mfma_f32_32x32x16_bf16 v[32:47], v[200:203], v[128:131], v[32:47]
    v_exp_f32 v120, v120
    v_exp_f32 v121, v121
    v_exp_f32 v122, v122
    v_exp_f32 v123, v123
    v_cvt_pk_bf16_f32 v140, v120, v121
    v_cvt_pk_bf16_f32 v141, v122, v123
    v_mfma_f32_32x32x16_bf16 v[32:47], v[204:207], v[132:135], v[32:47]
    v_exp_f32 v124, v124
    v_exp_f32 v125, v125
    v_exp_f32 v126, v126
    v_exp_f32 v127, v127
    v_cvt_pk_bf16_f32 v142, v124, v125
    v_cvt_pk_bf16_f32 v143, v126, v127
    s_cbranch_scc1 P2_loop
    v_mfma_f32_32x32x16_bf16 v[48:63], v[200:203], v[136:139], v[48:63]
    v_mfma_f32_32x32x16_bf16 v[48:63], v[204:207], v[140:143], v[48:63]
    s_waitcnt vmcnt(0)
    v_mov_b32 v210, 8
    v_mov_b32 v211, 1
    v_cmp_eq_u32 vcc, 1, v209
    s_nop 1
    v_cndmask_b32 v210, v210, v211, vcc
    s_mov_b32 s60, 2000000
    s_branch G_pchk6
G_poll6:
    global_load_dword v223, v213, s[4:5] sc1
    s_waitcnt vmcnt(0)
G_pchk6:
    v_cmp_le_u32 vcc, v210, v223
    s_sub_u32 s60, s60, 1
    s_cmp_eq_u32 s60, 0
    s_cbranch_scc1 G_pend6
    s_cmp_eq_u64 vcc, -1
    s_cbranch_scc1 G_pend6
    s_sleep 4
    s_branch G_poll6
G_pend6:
    s_lshl_b32 s14, s11, 11
    v_add_u32 v210, s14, v208
    s_lshl_b32 s14, s11, 3
    s_add_u32 s14, s14, 4096
    v_add_u32 v211, s14, v208
    v_lshlrev_b32 v212, 3, v209
    global_load_dwordx4 v[144:147], v210, s[38:39] sc1
    global_load_dwordx4 v[148:151], v210, s[38:39] offset:1024 sc1
    global_load_dwordx2 v[152:153], v211, s[38:39] sc1
    global_load_dwordx4 v[160:163], v208, s[46:47] sc1
    global_load_dwordx4 v[164:167], v208, s[46:47] offset:1024 sc1
    global_load_dwordx2 v[168:169], v212, s[46:47] offset:2048 sc1
    s_cmp_lg_u32 s12, 0
    s_cbranch_scc1 P2_red1
    ds_write_b128 v218, v[16:19] offset:15360
    ds_write_b128 v218, v[20:23] offset:16384
    ds_write_b128 v218, v[24:27] offset:17408
    ds_write_b128 v218, v[32:35] offset:21504
    ds_write_b128 v218, v[36:39] offset:22528
    ds_write_b128 v218, v[40:43] offset:23552
    s_nop 7
    ds_write_b128 v218, v[48:51] offset:27648
    ds_write_b128 v218, v[52:55] offset:28672
    ds_write_b128 v218, v[56:59] offset:29696
    s_waitcnt lgkmcnt(0)
    s_barrier
    ds_read_b128 v[96:99], v219 offset:0
    ds_read_b128 v[100:103], v219 offset:1024
    ds_read_b128 v[104:107], v219 offset:2048
    ds_read_b128 v[108:111], v219 offset:3072
    ds_read_b128 v[112:115], v219 offset:4096
    ds_read_b128 v[116:119], v219 offset:5120
    ds_read_b128 v[120:123], v219 offset:6144
    ds_read_b128 v[124:127], v219 offset:7168
    ds_read_b128 v[128:131], v219 offset:8192
    s_waitcnt lgkmcnt(6)
    v_pk_add_f32 v[96:97], v[96:97], v[0:1]
    v_pk_add_f32 v[98:99], v[98:99], v[2:3]
    v_pk_add_f32 v[100:101], v[100:101], v[4:5]
    v_pk_add_f32 v[102:103], v[102:103], v[6:7]
    v_pk_add_f32 v[104:105], v[104:105], v[8:9]
    v_pk_add_f32 v[106:107], v[106:107], v[10:11]
    s_branch P2_redj
P2_red1:
    s_cmp_lg_u32 s12, 1
    s_cbranch_scc1 P2_red2
    ds_write_b128 v218, v[0:3] offset:0
    ds_write_b128 v218, v[4:7] offset:1024
    ds_write_b128 v218, v[8:11] offset:2048
    ds_write_b128 v218, v[32:35] offset:24576
    ds_write_b128 v218, v[36:39] offset:25600
    ds_write_b128 v218, v[40:43] offset:26624
    s_nop 7
    ds_write_b128 v218, v[48:51] offset:30720
    ds_write_b128 v218, v[52:55] offset:31744
    ds_write_b128 v218, v[56:59] offset:32768
    s_waitcnt lgkmcnt(0)
    s_barrier
    ds_read_b128 v[96:99], v219 offset:0
    ds_read_b128 v[100:103], v219 offset:1024
    ds_read_b128 v[104:107], v219 offset:2048
    ds_read_b128 v[108:111], v219 offset:3072
    ds_read_b128 v[112:115], v219 offset:4096
    ds_read_b128 v[116:119], v219 offset:5120
    ds_read_b128 v[120:123], v219 offset:6144
    ds_read_b128 v[124:127], v219 offset:7168
    ds_read_b128 v[128:131], v219 offset:8192
    s_waitcnt lgkmcnt(6)
    v_pk_add_f32 v[96:97], v[96:97], v[16:17]
    v_pk_add_f32 v[98:99], v[98:99], v[18:19]
    v_pk_add_f32 v[100:101], v[100:101], v[20:21]
    v_pk_add_f32 v[102:103], v[102:103], v[22:23]
    v_pk_add_f32 v[104:105], v[104:105], v[24:25]
    v_pk_add_f32 v[106:107], v[106:107], v[26:27]
    s_branch P2_redj
P2_red2:
    s_cmp_lg_u32 s12, 2
    s_cbranch_scc1 P2_red3
    ds_write_b128 v218, v[0:3] offset:3072
    ds_write_b128 v218, v[4:7] offset:4096
    ds_write_b128 v218, v[8:11] offset:5120
    ds_write_b128 v218, v[16:19] offset:9216
    ds_write_b128 v218, v[20:23] offset:10240
    ds_write_b128 v218, v[24:27] offset:11264
    s_nop 7
    ds_write_b128 v218, v[48:51] offset:33792
    ds_write_b128 v218, v[52:55] offset:34816
    ds_write_b128 v218, v[56:59] offset:35840
    s_waitcnt lgkmcnt(0)
    s_barrier
    ds_read_b128 v[96:99], v219 offset:0
    ds_read_b128 v[100:103], v219 offset:1024
    ds_read_b128 v[104:107], v219 offset:2048
    ds_read_b128 v[108:111], v219 offset:3072
    ds_read_b128 v[112:115], v219 offset:4096
    ds_read_b128 v[116:119], v219 offset:5120
    ds_read_b128 v[120:123], v219 offset:6144
    ds_read_b128 v[124:127], v219 offset:7168
    ds_read_b128 v[128:131], v219 offset:8192
    s_waitcnt lgkmcnt(6)
    v_pk_add_f32 v[96:97], v[96:97], v[32:33]
    v_pk_add_f32 v[98:99], v[98:99], v[34:35]
    v_pk_add_f32 v[100:101], v[100:101], v[36:37]
    v_pk_add_f32 v[102:103], v[102:103], v[38:39]
    v_pk_add_f32 v[104:105], v[104:105], v[40:41]
    v_pk_add_f32 v[106:107], v[106:107], v[42:43]
    s_branch P2_redj
P2_red3:
    ds_write_b128 v218, v[0:3] offset:6144
    ds_write_b128 v218, v[4:7] offset:7168
    ds_write_b128 v218, v[8:11] offset:8192
    ds_write_b128 v218, v[16:19] offset:12288
    ds_write_b128 v218, v[20:23] offset:13312
    ds_write_b128 v218, v[24:27] offset:14336
    ds_write_b128 v218, v[32:35] offset:18432
    ds_write_b128 v218, v[36:39] offset:19456
    ds_write_b128 v218, v[40:43] offset:20480
    s_waitcnt lgkmcnt(0)
    s_barrier
    ds_read_b128 v[96:99], v219 offset:0
    ds_read_b128 v[100:103], v219 offset:1024
    ds_read_b128 v[104:107], v219 offset:2048
    ds_read_b128 v[108:111], v219 offset:3072
    ds_read_b128 v[112:115], v219 offset:4096
    ds_read_b128 v[116:119], v219 offset:5120
    ds_read_b128 v[120:123], v219 offset:6144
    ds_read_b128 v[124:127], v219 offset:7168
    ds_read_b128 v[128:131], v219 offset:8192
    s_nop 3
    s_waitcnt lgkmcnt(6)
    v_pk_add_f32 v[96:97], v[96:97], v[48:49]
    v_pk_add_f32 v[98:99], v[98:99], v[50:51]
    v_pk_add_f32 v[100:101], v[100:101], v[52:53]
    v_pk_add_f32 v[102:103], v[102:103], v[54:55]
    v_pk_add_f32 v[104:105], v[104:105], v[56:57]
    v_pk_add_f32 v[106:107], v[106:107], v[58:59]
P2_redj:
    v_mov_b32 v170, 0
    v_mov_b32 v171, 0
    v_mov_b32 v154, 0
    v_mov_b32 v155, 0
    s_waitcnt lgkmcnt(0)
    v_pk_add_f32 v[108:109], v[108:109], v[120:121]
    v_pk_add_f32 v[110:111], v[110:111], v[122:123]
    v_pk_add_f32 v[112:113], v[112:113], v[124:125]
    v_pk_add_f32 v[114:115], v[114:115], v[126:127]
    v_pk_add_f32 v[116:117], v[116:117], v[128:129]
    v_pk_add_f32 v[118:119], v[118:119], v[130:131]
    s_waitcnt vmcnt(0)
    v_mfma_f32_32x32x16_bf16 v[32:47], v[160:163], v[144:147], 0
    v_mfma_f32_32x32x16_bf16 v[32:47], v[164:167], v[148:151], v[32:47]
    v_mfma_f32_32x32x16_bf16 v[32:47], v[168:171], v[152:155], v[32:47]
    v_pk_add_f32 v[104:105], v[104:105], v[116:117]
    v_pk_add_f32 v[106:107], v[106:107], v[118:119]
    v_pk_add_f32 v[96:97], v[96:97], v[108:109]
    v_pk_add_f32 v[98:99], v[98:99], v[110:111]
    v_pk_add_f32 v[100:101], v[100:101], v[112:113]
    v_pk_add_f32 v[102:103], v[102:103], v[114:115]
    v_mov_b32 v212, v104
    v_mov_b32 v213, v104
    s_nop 1
    v_permlane32_swap_b32 v212, v213
    v_rcp_f32 v212, v213
    s_nop 0
    v_pk_mul_f32 v[96:97], v[96:97], v[212:213] op_sel_hi:[1,0]
    v_pk_mul_f32 v[98:99], v[98:99], v[212:213] op_sel_hi:[1,0]
    v_pk_mul_f32 v[100:101], v[100:101], v[212:213] op_sel_hi:[1,0]
    v_pk_mul_f32 v[102:103], v[102:103], v[212:213] op_sel_hi:[1,0]
    v_pk_mul_f32 v[104:105], v[104:105], v[212:213] op_sel_hi:[1,0]
    v_pk_mul_f32 v[106:107], v[106:107], v[212:213] op_sel_hi:[1,0]
    v_cvt_pk_bf16_f32 v108, v96, v97
    v_cvt_pk_bf16_f32 v109, v98, v99
    v_cvt_pk_bf16_f32 v110, v100, v101
    v_cvt_pk_bf16_f32 v111, v102, v103
    v_cvt_pk_bf16_f32 v112, v104, v105
    v_cvt_pk_bf16_f32 v113, v106, v107
    ds_write_b64 v215, v[108:109]
    ds_write_b64 v216, v[110:111]
    s_mov_b64 exec, s[16:17]
    ds_write_b64 v217, v[112:113]
    s_mov_b64 exec, -1
    s_mov_b32 s14, 0x21800000
    s_mov_b32 s15, 0x7b800000
    v_cmp_le_f32 vcc, s14, v213
    v_cmp_ge_f32 s[30:31], s15, v213
    s_nop 1
    s_and_b64 vcc, vcc, s[30:31]
    s_cmp_eq_u64 vcc, -1
    s_cbranch_scc0 P2_fb
P2_afterA:
    v_mov_b32 v212, v40
    v_mov_b32 v213, v40
    s_nop 1
    v_permlane32_swap_b32 v212, v213
    v_add_f32 v213, 0x358637bd, v213
    v_rcp_f32 v212, v213
    s_nop 0
    v_pk_mul_f32 v[32:33], v[32:33], v[212:213] op_sel_hi:[1,0]
    v_pk_mul_f32 v[34:35], v[34:35], v[212:213] op_sel_hi:[1,0]
    v_pk_mul_f32 v[36:37], v[36:37], v[212:213] op_sel_hi:[1,0]
    v_pk_mul_f32 v[38:39], v[38:39], v[212:213] op_sel_hi:[1,0]
    v_pk_mul_f32 v[40:41], v[40:41], v[212:213] op_sel_hi:[1,0]
    v_pk_mul_f32 v[42:43], v[42:43], v[212:213] op_sel_hi:[1,0]
    v_cvt_pk_bf16_f32 v44, v32, v33
    v_cvt_pk_bf16_f32 v45, v34, v35
    v_cvt_pk_bf16_f32 v46, v36, v37
    v_cvt_pk_bf16_f32 v47, v38, v39
    v_cvt_pk_bf16_f32 v48, v40, v41
    v_cvt_pk_bf16_f32 v49, v42, v43
    ds_write_b64 v220, v[44:45]
    ds_write_b64 v221, v[46:47]
    s_mov_b64 exec, s[16:17]
    ds_write_b64 v222, v[48:49]
    s_mov_b64 exec, -1
    s_waitcnt lgkmcnt(0)
    s_barrier
    s_add_u32 s14, s10, 0
    s_lshl_b32 s15, s14, 10
    s_add_u32 s42, s15, 122880
    v_add_u32 v210, s42, v208
    ds_read_b128 v[96:99], v210
    s_cmp_ge_u32 s14, 10
    s_cselect_b32 s42, 3135488, 0
    s_add_u32 s15, s15, s42
    v_add_u32 v215, s15, v208
    s_add_u32 s14, s10, 8
    s_lshl_b32 s15, s14, 10
    s_add_u32 s42, s15, 122880
    v_add_u32 v210, s42, v208
    ds_read_b128 v[100:103], v210
    s_cmp_ge_u32 s14, 10
    s_cselect_b32 s42, 3135488, 0
    s_add_u32 s15, s15, s42
    v_add_u32 v216, s15, v208
    s_cmp_ge_u32 s10, 4
    s_cbranch_scc1 P2_stdone
    s_add_u32 s14, s10, 16
    s_lshl_b32 s15, s14, 10
    s_add_u32 s42, s15, 122880
    v_add_u32 v210, s42, v208
    ds_read_b128 v[104:107], v210
    s_cmp_ge_u32 s14, 10
    s_cselect_b32 s42, 3135488, 0
    s_add_u32 s15, s15, s42
    v_add_u32 v217, s15, v208
    s_waitcnt lgkmcnt(0)
    global_store_dwordx4 v217, v[104:107], s[36:37] sc1
P2_stdone:
    s_waitcnt lgkmcnt(0)
    global_store_dwordx4 v215, v[96:99], s[36:37] sc1
    global_store_dwordx4 v216, v[100:103], s[36:37] sc1
    s_branch P2_done
P2_fb:
    s_cmp_lg_u32 s12, 0
    s_cbranch_scc1 P2_fq1
    v_mov_b32 v120, v64
    v_mov_b32 v121, v65
    v_mov_b32 v122, v66
    v_mov_b32 v123, v67
    v_mov_b32 v126, v88
    v_mov_b32 v127, v89
    s_branch P2_fqj
P2_fq1:
    s_cmp_lg_u32 s12, 1
    s_cbranch_scc1 P2_fq2
    v_mov_b32 v120, v68
    v_mov_b32 v121, v69
    v_mov_b32 v122, v70
    v_mov_b32 v123, v71
    v_mov_b32 v126, v88
    v_mov_b32 v127, v89
    s_branch P2_fqj
P2_fq2:
    s_cmp_lg_u32 s12, 2
    s_cbranch_scc1 P2_fq3
    v_mov_b32 v120, v72
    v_mov_b32 v121, v73
    v_mov_b32 v122, v74
    v_mov_b32 v123, v75
    v_mov_b32 v126, v92
    v_mov_b32 v127, v93
    s_branch P2_fqj
P2_fq3:
    v_mov_b32 v120, v76
    v_mov_b32 v121, v77
    v_mov_b32 v122, v78
    v_mov_b32 v123, v79
    v_mov_b32 v126, v92
    v_mov_b32 v127, v93
P2_fqj:
    s_and_b32 s14, s12, 1
    s_cmp_eq_u32 s14, 0
    s_cselect_b64 s[40:41], s[16:17], s[18:19]
    s_lshl_b32 s14, s14, 3
    v_add_u32 v218, s14, v208
    s_add_u32 s28, s4, 4194304
    s_addc_u32 s29, s5, 0
    v_cndmask_b32 v124, 0, v126, s[40:41]
    v_cndmask_b32 v125, 0, v127, s[40:41]
    v_mov_b32 v219, 0xff800000
    s_mov_b32 s6, s28
    s_mov_b32 s7, s29
    s_mov_b32 s13, 64
P2_fl0:
    global_load_dwordx4 v[8:11], v208, s[6:7] sc1
    global_load_dwordx2 v[12:13], v218, s[6:7] offset:1024 sc1
    s_add_u32 s6, s6, 4096
    s_addc_u32 s7, s7, 0
    s_waitcnt vmcnt(0)
    v_mfma_f32_32x32x16_bf16 v[176:191], v[8:11], v[120:123], 0
    v_mfma_f32_32x32x8_bf16 v[176:191], v[12:13], v[124:125], v[176:191]
    s_nop 7
    s_nop 7
    v_max3_f32 v219, v176, v177, v219
    v_max3_f32 v219, v178, v179, v219
    v_max3_f32 v219, v180, v181, v219
    v_max3_f32 v219, v182, v183, v219
    v_max3_f32 v219, v184, v185, v219
    v_max3_f32 v219, v186, v187, v219
    v_max3_f32 v219, v188, v189, v219
    v_max3_f32 v219, v190, v191, v219
    s_sub_u32 s13, s13, 1
    s_cmp_lg_u32 s13, 0
    s_cbranch_scc1 P2_fl0
    v_mov_b32 v212, v219
    v_mov_b32 v210, v219
    s_nop 1
    v_permlane32_swap_b32 v212, v210
    v_max_f32 v219, v212, v210
    v_sub_f32 v176, 0, v219
    v_cvt_pk_bf16_f32 v177, v176, 0
    v_lshlrev_b32 v177, 16, v177
    v_sub_f32 v176, v176, v177
    v_cvt_pk_bf16_f32 v178, v176, 0
    v_lshlrev_b32 v178, 16, v178
    v_sub_f32 v176, v176, v178
    v_cvt_pk_bf16_f32 v180, v176, 0
    v_cvt_pk_bf16_f32 v179, v177, v178
    v_cndmask_b32 v124, v179, v126, s[40:41]
    v_cndmask_b32 v125, v180, v127, s[40:41]
    s_mov_b32 s6, s28
    s_mov_b32 s7, s29
    s_mov_b32 s13, 64
    v_mov_b32 v128, 0
    v_mov_b32 v129, 0
    v_mov_b32 v130, 0
    v_mov_b32 v131, 0
    v_mov_b32 v132, 0
    v_mov_b32 v133, 0
    v_mov_b32 v134, 0
    v_mov_b32 v135, 0
    v_mov_b32 v136, 0
    v_mov_b32 v137, 0
    v_mov_b32 v138, 0
    v_mov_b32 v139, 0
    v_mov_b32 v140, 0
    v_mov_b32 v141, 0
    v_mov_b32 v142, 0
    v_mov_b32 v143, 0
P2_fl1:
    global_load_dwordx4 v[8:11], v208, s[6:7] sc1
    global_load_dwordx2 v[12:13], v218, s[6:7] offset:1024 sc1
    global_load_dwordx4 v[14:17], v208, s[6:7] offset:2048 sc1
    global_load_dwordx4 v[18:21], v208, s[6:7] offset:3072 sc1
    s_add_u32 s6, s6, 4096
    s_addc_u32 s7, s7, 0
    s_waitcnt vmcnt(0)
    v_mfma_f32_32x32x16_bf16 v[176:191], v[8:11], v[120:123], 0
    v_mfma_f32_32x32x8_bf16 v[176:191], v[12:13], v[124:125], v[176:191]
    s_nop 7
    s_nop 7
    v_exp_f32 v176, v176
    v_exp_f32 v177, v177
    v_exp_f32 v178, v178
    v_exp_f32 v179, v179
    v_exp_f32 v180, v180
    v_exp_f32 v181, v181
    v_exp_f32 v182, v182
    v_exp_f32 v183, v183
    v_exp_f32 v184, v184
    v_exp_f32 v185, v185
    v_exp_f32 v186, v186
    v_exp_f32 v187, v187
    v_exp_f32 v188, v188
    v_exp_f32 v189, v189
    v_exp_f32 v190, v190
    v_exp_f32 v191, v191
    v_cvt_pk_bf16_f32 v0, v176, v177
    v_cvt_pk_bf16_f32 v1, v178, v179
    v_cvt_pk_bf16_f32 v2, v180, v181
    v_cvt_pk_bf16_f32 v3, v182, v183
    v_cvt_pk_bf16_f32 v4, v184, v185
    v_cvt_pk_bf16_f32 v5, v186, v187
    v_cvt_pk_bf16_f32 v6, v188, v189
    v_cvt_pk_bf16_f32 v7, v190, v191
    v_mfma_f32_32x32x16_bf16 v[128:143], v[14:17], v[0:3], v[128:143]
    s_nop 0
    v_mfma_f32_32x32x16_bf16 v[128:143], v[18:21], v[4:7], v[128:143]
    s_nop 7
    s_nop 7
    s_sub_u32 s13, s13, 1
    s_cmp_lg_u32 s13, 0
    s_cbranch_scc1 P2_fl1
    v_mov_b32 v96, v128
    v_mov_b32 v97, v129
    v_mov_b32 v98, v130
    v_mov_b32 v99, v131
    v_mov_b32 v100, v132
    v_mov_b32 v101, v133
    v_mov_b32 v102, v134
    v_mov_b32 v103, v135
    v_mov_b32 v104, v136
    v_mov_b32 v105, v137
    v_mov_b32 v106, v138
    v_mov_b32 v107, v139
    v_mov_b32 v212, v104
    v_mov_b32 v213, v104
    s_nop 1
    v_permlane32_swap_b32 v212, v213
    v_rcp_f32 v212, v213
    s_nop 0
    v_pk_mul_f32 v[96:97], v[96:97], v[212:213] op_sel_hi:[1,0]
    v_pk_mul_f32 v[98:99], v[98:99], v[212:213] op_sel_hi:[1,0]
    v_pk_mul_f32 v[100:101], v[100:101], v[212:213] op_sel_hi:[1,0]
    v_pk_mul_f32 v[102:103], v[102:103], v[212:213] op_sel_hi:[1,0]
    v_pk_mul_f32 v[104:105], v[104:105], v[212:213] op_sel_hi:[1,0]
    v_pk_mul_f32 v[106:107], v[106:107], v[212:213] op_sel_hi:[1,0]
    v_cvt_pk_bf16_f32 v108, v96, v97
    v_cvt_pk_bf16_f32 v109, v98, v99
    v_cvt_pk_bf16_f32 v110, v100, v101
    v_cvt_pk_bf16_f32 v111, v102, v103
    v_cvt_pk_bf16_f32 v112, v104, v105
    v_cvt_pk_bf16_f32 v113, v106, v107
    ds_write_b64 v215, v[108:109]
    ds_write_b64 v216, v[110:111]
    s_mov_b64 exec, s[16:17]
    ds_write_b64 v217, v[112:113]
    s_mov_b64 exec, -1
    s_branch P2_afterA
P2_done:
    s_setprio 0
    s_waitcnt vmcnt(0) lgkmcnt(0)
    s_barrier
    s_cmp_eq_u32 s96, 1
    s_cbranch_scc0 P2_nosig
    s_lshl_b32 s14, s2, 6
    s_add_u32 s14, s14, 22053888
    v_mov_b32 v232, s14
    v_mov_b32 v233, 1
    s_mov_b64 exec, 1
    global_store_dword v232, v233, s[4:5] sc1
    s_mov_b64 exec, -1
P2_nosig:
    s_load_dwordx2 s[6:7], s[0:1], 32
    s_load_dwordx2 s[8:9], s[0:1], 64
    s_load_dwordx2 s[20:21], s[0:1], 72
    v_mov_b32 v200, v228
    v_mov_b32 v201, v229
    s_mov_b32 s10, s96
    s_and_b32 s14, s2, 7
    s_lshr_b32 s15, s2, 3
    s_lshr_b32 s11, s14, 2
    s_and_b32 s14, s14, 3
    s_lshl_b32 s14, s14, 3
    s_lshr_b32 s12, s15, 2
    s_add_u32 s12, s12, s14
    s_and_b32 s13, s15, 3
    s_lshr_b32 s26, s15, 2
    s_mul_i32 s14, s13, 3
    s_add_u32 s26, s26, s14
    s_cmp_ge_u32 s26, 10
    s_cselect_b32 s14, 10, 0
    s_sub_u32 s26, s26, s14
    s_cmp_ge_u32 s10, 4
    s_cbranch_scc1 P3_lpre
    s_and_b32 s22, s10, 1
    s_lshr_b32 s23, s10, 1
    s_lshl_b32 s14, s12, 1
    s_add_u32 s14, s14, s22
    s_mul_i32 s14, s14, 40
    s_mul_i32 s15, s23, 20
    s_add_u32 s14, s14, s15
    s_lshl_b32 s15, s26, 1
    s_add_u32 s14, s14, s15
    s_lshl_b32 s14, s14, 10
    s_mul_i32 s15, s11, 3145728
    s_add_u32 s14, s14, s15
    s_add_u32 s14, s14, 5242880
    s_add_u32 s18, s4, s14
    s_addc_u32 s19, s5, 0
    s_mov_b32 s27, s26
    s_mov_b32 s28, 2048
    v_lshrrev_b32 v202, 5, v200
    v_lshlrev_b32 v202, 3, v202
    v_bfe_u32 v205, v200, 2, 2
    v_add_u32 v202, v202, v205
    v_mul_u32_u24 v202, 320, v202
    v_bfe_u32 v205, v200, 4, 1
    v_lshl_add_u32 v202, v205, 5, v202
    v_and_b32 v205, 3, v200
    v_lshl_add_u32 v204, v205, 3, v202
    s_mul_i32 s14, s23, 10240
    v_add_u32 v206, s14, v204
    v_add_u32 v207, 61440, v206
    s_mul_i32 s29, s10, 5632
    s_add_u32 s29, s29, 40960
    v_add_u32 v202, 0, v200
    v_mul_u32_u24 v203, 6554, v202
    v_lshrrev_b32 v203, 16, v203
    v_lshlrev_b32 v205, 4, v202
    v_lshl_add_u32 v213, v203, 4, v205
    v_add_u32 v213, s29, v213
    v_mul_u32_u24 v203, 2400, v203
    v_add_u32 v208, v203, v205
    v_add_u32 v202, 64, v200
    v_mul_u32_u24 v203, 6554, v202
    v_lshrrev_b32 v203, 16, v203
    v_lshlrev_b32 v205, 4, v202
    v_lshl_add_u32 v214, v203, 4, v205
    v_add_u32 v214, s29, v214
    v_mul_u32_u24 v203, 2400, v203
    v_add_u32 v209, v203, v205
    v_add_u32 v202, 128, v200
    v_mul_u32_u24 v203, 6554, v202
    v_lshrrev_b32 v203, 16, v203
    v_lshlrev_b32 v205, 4, v202
    v_lshl_add_u32 v215, v203, 4, v205
    v_add_u32 v215, s29, v215
    v_mul_u32_u24 v203, 2400, v203
    v_add_u32 v210, v203, v205
    v_add_u32 v202, 192, v200
    v_mul_u32_u24 v203, 6554, v202
    v_lshrrev_b32 v203, 16, v203
    v_lshlrev_b32 v205, 4, v202
    v_lshl_add_u32 v216, v203, 4, v205
    v_add_u32 v216, s29, v216
    v_mul_u32_u24 v203, 2400, v203
    v_add_u32 v211, v203, v205
    v_add_u32 v202, 256, v200
    v_mul_u32_u24 v203, 6554, v202
    v_lshrrev_b32 v203, 16, v203
    v_lshlrev_b32 v205, 4, v202
    v_lshl_add_u32 v217, v203, 4, v205
    v_add_u32 v217, s29, v217
    v_mul_u32_u24 v203, 2400, v203
    v_add_u32 v212, v203, v205
    v_and_b32 v202, 31, v200
    v_mul_u32_u24 v202, 176, v202
    v_lshrrev_b32 v203, 5, v200
    v_lshl_add_u32 v202, v203, 3, v202
    v_add_u32 v218, s29, v202
    s_mul_i32 s14, s10, 10240
    v_add_u32 v219, s14, v201
    s_xor_b32 s15, s10, 2
    s_mul_i32 s15, s15, 10240
    v_add_u32 v220, s15, v201
    s_lshl_b32 s14, s12, 6
    s_lshl_b32 s15, s22, 5
    s_add_u32 s14, s14, s15
    s_mul_i32 s14, s14, 2560
    s_mul_i32 s15, s11, 1280
    s_add_u32 s14, s14, s15
    s_mul_i32 s15, s13, 320
    s_add_u32 s14, s14, s15
    s_mul_i32 s15, s23, 160
    s_add_u32 s14, s14, s15
    s_waitcnt lgkmcnt(0)
    s_add_u32 s20, s20, s14
    s_addc_u32 s21, s21, 0
    s_branch P3_prej
P3_lpre:
    s_sub_u32 s10, s10, 4
    s_lshr_b32 s23, s10, 1
    s_and_b32 s22, s10, 1
    v_add_u32 v202, 0, v200
    v_mul_u32_u24 v203, 3277, v202
    v_lshrrev_b32 v203, 16, v203
    v_mul_u32_u24 v204, 20, v203
    v_sub_u32 v204, v202, v204
    v_mul_u32_u24 v203, 1280, v203
    v_lshl_add_u32 v208, v204, 4, v203
    v_add_u32 v202, 64, v200
    v_mul_u32_u24 v203, 3277, v202
    v_lshrrev_b32 v203, 16, v203
    v_mul_u32_u24 v204, 20, v203
    v_sub_u32 v204, v202, v204
    v_mul_u32_u24 v203, 1280, v203
    v_lshl_add_u32 v209, v204, 4, v203
    v_add_u32 v202, 128, v200
    v_mul_u32_u24 v203, 3277, v202
    v_lshrrev_b32 v203, 16, v203
    v_mul_u32_u24 v204, 20, v203
    v_sub_u32 v204, v202, v204
    v_mul_u32_u24 v203, 1280, v203
    v_lshl_add_u32 v210, v204, 4, v203
    v_add_u32 v202, 192, v200
    v_mul_u32_u24 v203, 3277, v202
    v_lshrrev_b32 v203, 16, v203
    v_mul_u32_u24 v204, 20, v203
    v_sub_u32 v204, v202, v204
    v_mul_u32_u24 v203, 1280, v203
    v_lshl_add_u32 v211, v204, 4, v203
    v_add_u32 v202, 256, v200
    v_mul_u32_u24 v203, 3277, v202
    v_lshrrev_b32 v203, 16, v203
    v_mul_u32_u24 v204, 20, v203
    v_sub_u32 v204, v202, v204
    v_mul_u32_u24 v203, 1280, v203
    v_lshl_add_u32 v212, v204, 4, v203
    s_mul_i32 s14, s23, 409600
    s_mul_i32 s15, s22, 20480
    s_add_u32 s14, s14, s15
    s_mul_i32 s15, s13, 320
    s_add_u32 s14, s14, s15
    s_mul_i32 s15, s26, 40960
    s_add_u32 s14, s14, s15
    s_mul_i32 s25, s23, 10240
    s_mul_i32 s15, s22, 5120
    s_add_u32 s25, s25, s15
    s_waitcnt lgkmcnt(0)
    s_cmp_eq_u32 s11, 0
    s_cselect_b32 s16, s6, s8
    s_cselect_b32 s17, s7, s9
    s_add_u32 s16, s16, s14
    s_addc_u32 s17, s17, 0
    s_mov_b32 s27, s26
    s_mov_b32 s28, 40960
    s_add_u32 m0, s25, 0
    s_nop 0
    global_load_lds_dwordx4 v208, s[16:17]
    s_add_u32 m0, s25, 1024
    s_nop 0
    global_load_lds_dwordx4 v209, s[16:17]
    s_add_u32 m0, s25, 2048
    s_nop 0
    global_load_lds_dwordx4 v210, s[16:17]
    s_add_u32 m0, s25, 3072
    s_nop 0
    global_load_lds_dwordx4 v211, s[16:17]
    s_add_u32 m0, s25, 4096
    s_nop 0
    global_load_lds_dwordx4 v212, s[16:17]
    s_add_u32 s27, s27, 1
    s_cmp_eq_u32 s27, 10
    s_cselect_b32 s27, 0, s27
    s_cselect_b32 s14, -368640, s28
    s_ashr_i32 s30, s14, 31
    s_add_u32 s16, s16, s14
    s_addc_u32 s17, s17, s30
    s_add_u32 m0, s25, 20480
    s_nop 0
    global_load_lds_dwordx4 v208, s[16:17]
    s_add_u32 m0, s25, 21504
    s_nop 0
    global_load_lds_dwordx4 v209, s[16:17]
    s_add_u32 m0, s25, 22528
    s_nop 0
    global_load_lds_dwordx4 v210, s[16:17]
    s_add_u32 m0, s25, 23552
    s_nop 0
    global_load_lds_dwordx4 v211, s[16:17]
    s_add_u32 m0, s25, 24576
    s_nop 0
    global_load_lds_dwordx4 v212, s[16:17]
    s_add_u32 s27, s27, 1
    s_cmp_eq_u32 s27, 10
    s_cselect_b32 s27, 0, s27
    s_cselect_b32 s14, -368640, s28
    s_ashr_i32 s30, s14, 31
    s_add_u32 s16, s16, s14
    s_addc_u32 s17, s17, s30
    s_add_u32 m0, s25, 40960
    s_nop 0
    global_load_lds_dwordx4 v208, s[16:17]
    s_add_u32 m0, s25, 41984
    s_nop 0
    global_load_lds_dwordx4 v209, s[16:17]
    s_add_u32 m0, s25, 43008
    s_nop 0
    global_load_lds_dwordx4 v210, s[16:17]
    s_add_u32 m0, s25, 44032
    s_nop 0
    global_load_lds_dwordx4 v211, s[16:17]
    s_add_u32 m0, s25, 45056
    s_nop 0
    global_load_lds_dwordx4 v212, s[16:17]
    s_add_u32 s27, s27, 1
    s_cmp_eq_u32 s27, 10
    s_cselect_b32 s27, 0, s27
    s_cselect_b32 s14, -368640, s28
    s_ashr_i32 s30, s14, 31
    s_add_u32 s16, s16, s14
    s_addc_u32 s17, s17, s30
    s_add_u32 m0, s25, 61440
    s_nop 0
    global_load_lds_dwordx4 v208, s[16:17]
    s_add_u32 m0, s25, 62464
    s_nop 0
    global_load_lds_dwordx4 v209, s[16:17]
    s_add_u32 m0, s25, 63488
    s_nop 0
    global_load_lds_dwordx4 v210, s[16:17]
    s_add_u32 m0, s25, 64512
    s_nop 0
    global_load_lds_dwordx4 v211, s[16:17]
    s_add_u32 m0, s25, 65536
    s_nop 0
    global_load_lds_dwordx4 v212, s[16:17]
    s_add_u32 s27, s27, 1
    s_cmp_eq_u32 s27, 10
    s_cselect_b32 s27, 0, s27
    s_cselect_b32 s14, -368640, s28
    s_ashr_i32 s30, s14, 31
    s_add_u32 s16, s16, s14
    s_addc_u32 s17, s17, s30
    s_add_u32 m0, s25, 81920
    s_nop 0
    global_load_lds_dwordx4 v208, s[16:17]
    s_add_u32 m0, s25, 82944
    s_nop 0
    global_load_lds_dwordx4 v209, s[16:17]
    s_add_u32 m0, s25, 83968
    s_nop 0
    global_load_lds_dwordx4 v210, s[16:17]
    s_add_u32 m0, s25, 84992
    s_nop 0
    global_load_lds_dwordx4 v211, s[16:17]
    s_add_u32 m0, s25, 86016
    s_nop 0
    global_load_lds_dwordx4 v212, s[16:17]
    s_add_u32 s27, s27, 1
    s_cmp_eq_u32 s27, 10
    s_cselect_b32 s27, 0, s27
    s_cselect_b32 s14, -368640, s28
    s_ashr_i32 s30, s14, 31
    s_add_u32 s16, s16, s14
    s_addc_u32 s17, s17, s30
    s_add_u32 m0, s25, 102400
    s_nop 0
    global_load_lds_dwordx4 v208, s[16:17]
    s_add_u32 m0, s25, 103424
    s_nop 0
    global_load_lds_dwordx4 v209, s[16:17]
    s_add_u32 m0, s25, 104448
    s_nop 0
    global_load_lds_dwordx4 v210, s[16:17]
    s_add_u32 m0, s25, 105472
    s_nop 0
    global_load_lds_dwordx4 v211, s[16:17]
    s_add_u32 m0, s25, 106496
    s_nop 0
    global_load_lds_dwordx4 v212, s[16:17]
P3_prej:
    s_cmp_eq_u32 s96, 0
    s_cbranch_scc0 P3_nopoll
    s_lshl_b32 s14, s12, 9
    s_add_u32 s14, s14, 22053888
    v_and_b32 v224, 7, v228
    v_lshlrev_b32 v224, 6, v224
    v_add_u32 v224, s14, v224
    v_mov_b32 v225, 1
    s_mov_b32 s60, 2000000
G_poll7:
    global_load_dword v226, v224, s[4:5] sc1
    s_waitcnt vmcnt(0)
G_pchk7:
    v_cmp_le_u32 vcc, v225, v226
    s_sub_u32 s60, s60, 1
    s_cmp_eq_u32 s60, 0
    s_cbranch_scc1 G_pend7
    s_cmp_eq_u64 vcc, -1
    s_cbranch_scc1 G_pend7
    s_sleep 4
    s_branch G_poll7
G_pend7:
P3_nopoll:
    s_barrier
    s_cmp_ge_u32 s96, 4
    s_cbranch_scc1 P3_loader
    global_load_dwordx4 v[80:83], v201, s[18:19] offset:0 sc1
    global_load_dwordx4 v[84:87], v201, s[18:19] offset:1024 sc1
    s_add_u32 s27, s27, 1
    s_cmp_eq_u32 s27, 10
    s_cselect_b32 s27, 0, s27
    s_cselect_b32 s14, -18432, s28
    s_ashr_i32 s30, s14, 31
    s_add_u32 s18, s18, s14
    s_addc_u32 s19, s19, s30
    global_load_dwordx4 v[88:91], v201, s[18:19] offset:0 sc1
    global_load_dwordx4 v[92:95], v201, s[18:19] offset:1024 sc1
    s_add_u32 s27, s27, 1
    s_cmp_eq_u32 s27, 10
    s_cselect_b32 s27, 0, s27
    s_cselect_b32 s14, -18432, s28
    s_ashr_i32 s30, s14, 31
    s_add_u32 s18, s18, s14
    s_addc_u32 s19, s19, s30
    global_load_dwordx4 v[96:99], v201, s[18:19] offset:0 sc1
    global_load_dwordx4 v[100:103], v201, s[18:19] offset:1024 sc1
    s_add_u32 s27, s27, 1
    s_cmp_eq_u32 s27, 10
    s_cselect_b32 s27, 0, s27
    s_cselect_b32 s14, -18432, s28
    s_ashr_i32 s30, s14, 31
    s_add_u32 s18, s18, s14
    s_addc_u32 s19, s19, s30
    global_load_dwordx4 v[104:107], v201, s[18:19] offset:0 sc1
    global_load_dwordx4 v[108:111], v201, s[18:19] offset:1024 sc1
    s_add_u32 s27, s27, 1
    s_cmp_eq_u32 s27, 10
    s_cselect_b32 s27, 0, s27
    s_cselect_b32 s14, -18432, s28
    s_ashr_i32 s30, s14, 31
    s_add_u32 s18, s18, s14
    s_addc_u32 s19, s19, s30
    global_load_dwordx4 v[112:115], v201, s[18:19] offset:0 sc1
    global_load_dwordx4 v[116:119], v201, s[18:19] offset:1024 sc1
    s_add_u32 s27, s27, 1
    s_cmp_eq_u32 s27, 10
    s_cselect_b32 s27, 0, s27
    s_cselect_b32 s14, -18432, s28
    s_ashr_i32 s30, s14, 31
    s_add_u32 s18, s18, s14
    s_addc_u32 s19, s19, s30
    global_load_dwordx4 v[120:123], v201, s[18:19] offset:0 sc1
    global_load_dwordx4 v[124:127], v201, s[18:19] offset:1024 sc1
.p2align 6
    s_barrier
    ds_read_b64_tr_b16 v[160:161], v206 offset:0
    ds_read_b64_tr_b16 v[162:163], v206 offset:1280
    ds_read_b64_tr_b16 v[164:165], v206 offset:64
    ds_read_b64_tr_b16 v[166:167], v206 offset:1344
    ds_read_b64_tr_b16 v[168:169], v206 offset:128
    ds_read_b64_tr_b16 v[170:171], v206 offset:1408
    ds_read_b64_tr_b16 v[172:173], v206 offset:192
    ds_read_b64_tr_b16 v[174:175], v206 offset:1472
    ds_read_b64_tr_b16 v[176:177], v206 offset:256
    ds_read_b64_tr_b16 v[178:179], v206 offset:1536
    s_waitcnt lgkmcnt(8) vmcnt(11)
    v_mfma_f32_32x32x16_bf16 v[0:15], v[160:163], v[80:83], 0
    s_waitcnt lgkmcnt(6)
    ds_read_b64_tr_b16 v[180:181], v206 offset:5120
    ds_read_b64_tr_b16 v[182:183], v206 offset:6400
    v_mfma_f32_32x32x16_bf16 v[16:31], v[164:167], v[80:83], 0
    s_waitcnt lgkmcnt(6)
    ds_read_b64_tr_b16 v[184:185], v206 offset:5184
    ds_read_b64_tr_b16 v[186:187], v206 offset:6464
    v_mfma_f32_32x32x16_bf16 v[32:47], v[168:171], v[80:83], 0
    s_waitcnt lgkmcnt(6)
    s_add_u32 s27, s27, 1
    s_cmp_eq_u32 s27, 10
    s_cselect_b32 s27, 0, s27
    s_cselect_b32 s14, -18432, s28
    s_ashr_i32 s30, s14, 31
    s_add_u32 s18, s18, s14
    s_addc_u32 s19, s19, s30
    global_load_dwordx4 v[128:131], v201, s[18:19] offset:0 sc1
    ds_read_b64_tr_b16 v[188:189], v206 offset:5248
    ds_read_b64_tr_b16 v[190:191], v206 offset:6528
    v_mfma_f32_32x32x16_bf16 v[48:63], v[172:175], v[80:83], 0
    s_waitcnt lgkmcnt(6)
    ds_read_b64_tr_b16 v[192:193], v206 offset:5312
    ds_read_b64_tr_b16 v[194:195], v206 offset:6592
    v_mfma_f32_32x32x16_bf16 v[64:79], v[176:179], v[80:83], 0
    s_waitcnt lgkmcnt(6) vmcnt(11)
    ds_read_b64_tr_b16 v[196:197], v206 offset:5376
    ds_read_b64_tr_b16 v[198:199], v206 offset:6656
    v_mfma_f32_32x32x16_bf16 v[0:15], v[180:183], v[84:87], v[0:15]
    s_waitcnt lgkmcnt(6)
    s_barrier
    ds_read_b64_tr_b16 v[160:161], v206 offset:20480
    ds_read_b64_tr_b16 v[162:163], v206 offset:21760
    v_mfma_f32_32x32x16_bf16 v[16:31], v[184:187], v[84:87], v[16:31]
    s_waitcnt lgkmcnt(6)
    ds_read_b64_tr_b16 v[164:165], v206 offset:20544
    ds_read_b64_tr_b16 v[166:167], v206 offset:21824
    v_mfma_f32_32x32x16_bf16 v[32:47], v[188:191], v[84:87], v[32:47]
    s_waitcnt lgkmcnt(6)
    global_load_dwordx4 v[132:135], v201, s[18:19] offset:1024 sc1
    ds_read_b64_tr_b16 v[168:169], v206 offset:20608
    ds_read_b64_tr_b16 v[170:171], v206 offset:21888
    v_mfma_f32_32x32x16_bf16 v[48:63], v[192:195], v[84:87], v[48:63]
    s_waitcnt lgkmcnt(6)
    ds_read_b64_tr_b16 v[172:173], v206 offset:20672
    ds_read_b64_tr_b16 v[174:175], v206 offset:21952
    v_mfma_f32_32x32x16_bf16 v[64:79], v[196:199], v[84:87], v[64:79]
    s_waitcnt lgkmcnt(6) vmcnt(11)
    ds_read_b64_tr_b16 v[176:177], v206 offset:20736
    ds_read_b64_tr_b16 v[178:179], v206 offset:22016
    v_mfma_f32_32x32x16_bf16 v[0:15], v[160:163], v[88:91], v[0:15]
    s_waitcnt lgkmcnt(6)
    ds_read_b64_tr_b16 v[180:181], v206 offset:25600
    ds_read_b64_tr_b16 v[182:183], v206 offset:26880
    v_mfma_f32_32x32x16_bf16 v[16:31], v[164:167], v[88:91], v[16:31]
    s_waitcnt lgkmcnt(6)
    ds_read_b64_tr_b16 v[184:185], v206 offset:25664
    ds_read_b64_tr_b16 v[186:187], v206 offset:26944
    v_mfma_f32_32x32x16_bf16 v[32:47], v[168:171], v[88:91], v[32:47]
    s_waitcnt lgkmcnt(6)
    s_add_u32 s27, s27, 1
    s_cmp_eq_u32 s27, 10
    s_cselect_b32 s27, 0, s27
    s_cselect_b32 s14, -18432, s28
    s_ashr_i32 s30, s14, 31
    s_add_u32 s18, s18, s14
    s_addc_u32 s19, s19, s30
    global_load_dwordx4 v[136:139], v201, s[18:19] offset:0 sc1
    ds_read_b64_tr_b16 v[188:189], v206 offset:25728
    ds_read_b64_tr_b16 v[190:191], v206 offset:27008
    v_mfma_f32_32x32x16_bf16 v[48:63], v[172:175], v[88:91], v[48:63]
    s_waitcnt lgkmcnt(6)
    ds_read_b64_tr_b16 v[192:193], v206 offset:25792
    ds_read_b64_tr_b16 v[194:195], v206 offset:27072
    v_mfma_f32_32x32x16_bf16 v[64:79], v[176:179], v[88:91], v[64:79]
    s_waitcnt lgkmcnt(6) vmcnt(11)
    ds_read_b64_tr_b16 v[196:197], v206 offset:25856
    ds_read_b64_tr_b16 v[198:199], v206 offset:27136
    v_mfma_f32_32x32x16_bf16 v[0:15], v[180:183], v[92:95], v[0:15]
    s_waitcnt lgkmcnt(6)
    s_barrier
    ds_read_b64_tr_b16 v[160:161], v206 offset:40960
    ds_read_b64_tr_b16 v[162:163], v206 offset:42240
    v_mfma_f32_32x32x16_bf16 v[16:31], v[184:187], v[92:95], v[16:31]
    s_waitcnt lgkmcnt(6)
    ds_read_b64_tr_b16 v[164:165], v206 offset:41024
    ds_read_b64_tr_b16 v[166:167], v206 offset:42304
    v_mfma_f32_32x32x16_bf16 v[32:47], v[188:191], v[92:95], v[32:47]
    s_waitcnt lgkmcnt(6)
    global_load_dwordx4 v[140:143], v201, s[18:19] offset:1024 sc1
    ds_read_b64_tr_b16 v[168:169], v206 offset:41088
    ds_read_b64_tr_b16 v[170:171], v206 offset:42368
    v_mfma_f32_32x32x16_bf16 v[48:63], v[192:195], v[92:95], v[48:63]
    s_waitcnt lgkmcnt(6)
    ds_read_b64_tr_b16 v[172:173], v206 offset:41152
    ds_read_b64_tr_b16 v[174:175], v206 offset:42432
    v_mfma_f32_32x32x16_bf16 v[64:79], v[196:199], v[92:95], v[64:79]
    s_waitcnt lgkmcnt(6) vmcnt(11)
    ds_read_b64_tr_b16 v[176:177], v206 offset:41216
    ds_read_b64_tr_b16 v[178:179], v206 offset:42496
    v_mfma_f32_32x32x16_bf16 v[0:15], v[160:163], v[96:99], v[0:15]
    s_waitcnt lgkmcnt(6)
    ds_read_b64_tr_b16 v[180:181], v206 offset:46080
    ds_read_b64_tr_b16 v[182:183], v206 offset:47360
    v_mfma_f32_32x32x16_bf16 v[16:31], v[164:167], v[96:99], v[16:31]
    s_waitcnt lgkmcnt(6)
    ds_read_b64_tr_b16 v[184:185], v206 offset:46144
    ds_read_b64_tr_b16 v[186:187], v206 offset:47424
    v_mfma_f32_32x32x16_bf16 v[32:47], v[168:171], v[96:99], v[32:47]
    s_waitcnt lgkmcnt(6)
    s_add_u32 s27, s27, 1
    s_cmp_eq_u32 s27, 10
    s_cselect_b32 s27, 0, s27
    s_cselect_b32 s14, -18432, s28
    s_ashr_i32 s30, s14, 31
    s_add_u32 s18, s18, s14
    s_addc_u32 s19, s19, s30
    global_load_dwordx4 v[144:147], v201, s[18:19] offset:0 sc1
    ds_read_b64_tr_b16 v[188:189], v206 offset:46208
    ds_read_b64_tr_b16 v[190:191], v206 offset:47488
    v_mfma_f32_32x32x16_bf16 v[48:63], v[172:175], v[96:99], v[48:63]
    s_waitcnt lgkmcnt(6)
    ds_read_b64_tr_b16 v[192:193], v206 offset:46272
    ds_read_b64_tr_b16 v[194:195], v206 offset:47552
    v_mfma_f32_32x32x16_bf16 v[64:79], v[176:179], v[96:99], v[64:79]
    s_waitcnt lgkmcnt(6) vmcnt(11)
    ds_read_b64_tr_b16 v[196:197], v206 offset:46336
    ds_read_b64_tr_b16 v[198:199], v206 offset:47616
    v_mfma_f32_32x32x16_bf16 v[0:15], v[180:183], v[100:103], v[0:15]
    s_waitcnt lgkmcnt(6)
    s_barrier
    ds_read_b64_tr_b16 v[160:161], v207 offset:0
    ds_read_b64_tr_b16 v[162:163], v207 offset:1280
    v_mfma_f32_32x32x16_bf16 v[16:31], v[184:187], v[100:103], v[16:31]
    s_waitcnt lgkmcnt(6)
    ds_read_b64_tr_b16 v[164:165], v207 offset:64
    ds_read_b64_tr_b16 v[166:167], v207 offset:1344
    v_mfma_f32_32x32x16_bf16 v[32:47], v[188:191], v[100:103], v[32:47]
    s_waitcnt lgkmcnt(6)
    global_load_dwordx4 v[148:151], v201, s[18:19] offset:1024 sc1
    ds_read_b64_tr_b16 v[168:169], v207 offset:128
    ds_read_b64_tr_b16 v[170:171], v207 offset:1408
    v_mfma_f32_32x32x16_bf16 v[48:63], v[192:195], v[100:103], v[48:63]
    s_waitcnt lgkmcnt(6)
    ds_read_b64_tr_b16 v[172:173], v207 offset:192
    ds_read_b64_tr_b16 v[174:175], v207 offset:1472
    v_mfma_f32_32x32x16_bf16 v[64:79], v[196:199], v[100:103], v[64:79]
    s_waitcnt lgkmcnt(6) vmcnt(11)
    ds_read_b64_tr_b16 v[176:177], v207 offset:256
    ds_read_b64_tr_b16 v[178:179], v207 offset:1536
    v_mfma_f32_32x32x16_bf16 v[0:15], v[160:163], v[104:107], v[0:15]
    s_waitcnt lgkmcnt(6)
    ds_read_b64_tr_b16 v[180:181], v207 offset:5120
    ds_read_b64_tr_b16 v[182:183], v207 offset:6400
    v_mfma_f32_32x32x16_bf16 v[16:31], v[164:167], v[104:107], v[16:31]
    s_waitcnt lgkmcnt(6)
    ds_read_b64_tr_b16 v[184:185], v207 offset:5184
    ds_read_b64_tr_b16 v[186:187], v207 offset:6464
    v_mfma_f32_32x32x16_bf16 v[32:47], v[168:171], v[104:107], v[32:47]
    s_waitcnt lgkmcnt(6)
    s_add_u32 s27, s27, 1
    s_cmp_eq_u32 s27, 10
    s_cselect_b32 s27, 0, s27
    s_cselect_b32 s14, -18432, s28
    s_ashr_i32 s30, s14, 31
    s_add_u32 s18, s18, s14
    s_addc_u32 s19, s19, s30
    global_load_dwordx4 v[152:155], v201, s[18:19] offset:0 sc1
    ds_read_b64_tr_b16 v[188:189], v207 offset:5248
    ds_read_b64_tr_b16 v[190:191], v207 offset:6528
    v_mfma_f32_32x32x16_bf16 v[48:63], v[172:175], v[104:107], v[48:63]
    s_waitcnt lgkmcnt(6)
    ds_read_b64_tr_b16 v[192:193], v207 offset:5312
    ds_read_b64_tr_b16 v[194:195], v207 offset:6592
    v_mfma_f32_32x32x16_bf16 v[64:79], v[176:179], v[104:107], v[64:79]
    s_waitcnt lgkmcnt(6) vmcnt(11)
    ds_read_b64_tr_b16 v[196:197], v207 offset:5376
    ds_read_b64_tr_b16 v[198:199], v207 offset:6656
    v_mfma_f32_32x32x16_bf16 v[0:15], v[180:183], v[108:111], v[0:15]
    s_waitcnt lgkmcnt(6)
    s_barrier
    ds_read_b64_tr_b16 v[160:161], v207 offset:20480
    ds_read_b64_tr_b16 v[162:163], v207 offset:21760
    v_mfma_f32_32x32x16_bf16 v[16:31], v[184:187], v[108:111], v[16:31]
    s_waitcnt lgkmcnt(6)
    ds_read_b64_tr_b16 v[164:165], v207 offset:20544
    ds_read_b64_tr_b16 v[166:167], v207 offset:21824
    v_mfma_f32_32x32x16_bf16 v[32:47], v[188:191], v[108:111], v[32:47]
    s_waitcnt lgkmcnt(6)
    global_load_dwordx4 v[156:159], v201, s[18:19] offset:1024 sc1
    ds_read_b64_tr_b16 v[168:169], v207 offset:20608
    ds_read_b64_tr_b16 v[170:171], v207 offset:21888
    v_mfma_f32_32x32x16_bf16 v[48:63], v[192:195], v[108:111], v[48:63]
    s_waitcnt lgkmcnt(6)
    ds_read_b64_tr_b16 v[172:173], v207 offset:20672
    ds_read_b64_tr_b16 v[174:175], v207 offset:21952
    v_mfma_f32_32x32x16_bf16 v[64:79], v[196:199], v[108:111], v[64:79]
    s_waitcnt lgkmcnt(6) vmcnt(11)
    ds_read_b64_tr_b16 v[176:177], v207 offset:20736
    ds_read_b64_tr_b16 v[178:179], v207 offset:22016
    v_mfma_f32_32x32x16_bf16 v[0:15], v[160:163], v[112:115], v[0:15]
    s_waitcnt lgkmcnt(6)
    ds_read_b64_tr_b16 v[180:181], v207 offset:25600
    ds_read_b64_tr_b16 v[182:183], v207 offset:26880
    v_mfma_f32_32x32x16_bf16 v[16:31], v[164:167], v[112:115], v[16:31]
    s_waitcnt lgkmcnt(6)
    ds_read_b64_tr_b16 v[184:185], v207 offset:25664
    ds_read_b64_tr_b16 v[186:187], v207 offset:26944
    v_mfma_f32_32x32x16_bf16 v[32:47], v[168:171], v[112:115], v[32:47]
    s_waitcnt lgkmcnt(6)
    ds_read_b64_tr_b16 v[188:189], v207 offset:25728
    ds_read_b64_tr_b16 v[190:191], v207 offset:27008
    v_mfma_f32_32x32x16_bf16 v[48:63], v[172:175], v[112:115], v[48:63]
    s_waitcnt lgkmcnt(6)
    ds_read_b64_tr_b16 v[192:193], v207 offset:25792
    ds_read_b64_tr_b16 v[194:195], v207 offset:27072
    v_mfma_f32_32x32x16_bf16 v[64:79], v[176:179], v[112:115], v[64:79]
    s_waitcnt lgkmcnt(6) vmcnt(10)
    ds_read_b64_tr_b16 v[196:197], v207 offset:25856
    ds_read_b64_tr_b16 v[198:199], v207 offset:27136
    v_mfma_f32_32x32x16_bf16 v[0:15], v[180:183], v[116:119], v[0:15]
    s_waitcnt lgkmcnt(6)
    s_barrier
    ds_read_b64_tr_b16 v[160:161], v207 offset:40960
    ds_read_b64_tr_b16 v[162:163], v207 offset:42240
    v_mfma_f32_32x32x16_bf16 v[16:31], v[184:187], v[116:119], v[16:31]
    s_waitcnt lgkmcnt(6)
    ds_read_b64_tr_b16 v[164:165], v207 offset:41024
    ds_read_b64_tr_b16 v[166:167], v207 offset:42304
    v_mfma_f32_32x32x16_bf16 v[32:47], v[188:191], v[116:119], v[32:47]
    s_waitcnt lgkmcnt(6)
    ds_read_b64_tr_b16 v[168:169], v207 offset:41088
    ds_read_b64_tr_b16 v[170:171], v207 offset:42368
    v_mfma_f32_32x32x16_bf16 v[48:63], v[192:195], v[116:119], v[48:63]
    s_waitcnt lgkmcnt(6)
    ds_read_b64_tr_b16 v[172:173], v207 offset:41152
    ds_read_b64_tr_b16 v[174:175], v207 offset:42432
    v_mfma_f32_32x32x16_bf16 v[64:79], v[196:199], v[116:119], v[64:79]
    s_waitcnt lgkmcnt(6) vmcnt(9)
    ds_read_b64_tr_b16 v[176:177], v207 offset:41216
    ds_read_b64_tr_b16 v[178:179], v207 offset:42496
    v_mfma_f32_32x32x16_bf16 v[0:15], v[160:163], v[120:123], v[0:15]
    s_waitcnt lgkmcnt(6)
    ds_read_b64_tr_b16 v[180:181], v207 offset:46080
    ds_read_b64_tr_b16 v[182:183], v207 offset:47360
    v_mfma_f32_32x32x16_bf16 v[16:31], v[164:167], v[120:123], v[16:31]
    s_waitcnt lgkmcnt(6)
    ds_read_b64_tr_b16 v[184:185], v207 offset:46144
    ds_read_b64_tr_b16 v[186:187], v207 offset:47424
    v_mfma_f32_32x32x16_bf16 v[32:47], v[168:171], v[120:123], v[32:47]
    s_waitcnt lgkmcnt(6)
    ds_read_b64_tr_b16 v[188:189], v207 offset:46208
    ds_read_b64_tr_b16 v[190:191], v207 offset:47488
    v_mfma_f32_32x32x16_bf16 v[48:63], v[172:175], v[120:123], v[48:63]
    s_waitcnt lgkmcnt(6)
    ds_read_b64_tr_b16 v[192:193], v207 offset:46272
    ds_read_b64_tr_b16 v[194:195], v207 offset:47552
    v_mfma_f32_32x32x16_bf16 v[64:79], v[176:179], v[120:123], v[64:79]
    s_waitcnt lgkmcnt(6) vmcnt(8)
    ds_read_b64_tr_b16 v[196:197], v207 offset:46336
    ds_read_b64_tr_b16 v[198:199], v207 offset:47616
    v_mfma_f32_32x32x16_bf16 v[0:15], v[180:183], v[124:127], v[0:15]
    s_waitcnt lgkmcnt(6)
    s_barrier
    ds_read_b64_tr_b16 v[160:161], v206 offset:0
    ds_read_b64_tr_b16 v[162:163], v206 offset:1280
    v_mfma_f32_32x32x16_bf16 v[16:31], v[184:187], v[124:127], v[16:31]
    s_waitcnt lgkmcnt(6)
    ds_read_b64_tr_b16 v[164:165], v206 offset:64
    ds_read_b64_tr_b16 v[166:167], v206 offset:1344
    v_mfma_f32_32x32x16_bf16 v[32:47], v[188:191], v[124:127], v[32:47]
    s_waitcnt lgkmcnt(6)
    ds_read_b64_tr_b16 v[168:169], v206 offset:128
    ds_read_b64_tr_b16 v[170:171], v206 offset:1408
    v_mfma_f32_32x32x16_bf16 v[48:63], v[192:195], v[124:127], v[48:63]
    s_waitcnt lgkmcnt(6)
    ds_read_b64_tr_b16 v[172:173], v206 offset:192
    ds_read_b64_tr_b16 v[174:175], v206 offset:1472
    v_mfma_f32_32x32x16_bf16 v[64:79], v[196:199], v[124:127], v[64:79]
    s_waitcnt lgkmcnt(6) vmcnt(7)
    ds_read_b64_tr_b16 v[176:177], v206 offset:256
    ds_read_b64_tr_b16 v[178:179], v206 offset:1536
    v_mfma_f32_32x32x16_bf16 v[0:15], v[160:163], v[128:131], v[0:15]
    s_waitcnt lgkmcnt(6)
    ds_read_b64_tr_b16 v[180:181], v206 offset:5120
    ds_read_b64_tr_b16 v[182:183], v206 offset:6400
    v_mfma_f32_32x32x16_bf16 v[16:31], v[164:167], v[128:131], v[16:31]
    s_waitcnt lgkmcnt(6)
    ds_read_b64_tr_b16 v[184:185], v206 offset:5184
    ds_read_b64_tr_b16 v[186:187], v206 offset:6464
    v_mfma_f32_32x32x16_bf16 v[32:47], v[168:171], v[128:131], v[32:47]
    s_waitcnt lgkmcnt(6)
    ds_read_b64_tr_b16 v[188:189], v206 offset:5248
    ds_read_b64_tr_b16 v[190:191], v206 offset:6528
    v_mfma_f32_32x32x16_bf16 v[48:63], v[172:175], v[128:131], v[48:63]
    s_waitcnt lgkmcnt(6)
    ds_read_b64_tr_b16 v[192:193], v206 offset:5312
    ds_read_b64_tr_b16 v[194:195], v206 offset:6592
    v_mfma_f32_32x32x16_bf16 v[64:79], v[176:179], v[128:131], v[64:79]
    s_waitcnt lgkmcnt(6) vmcnt(6)
    ds_read_b64_tr_b16 v[196:197], v206 offset:5376
    ds_read_b64_tr_b16 v[198:199], v206 offset:6656
    v_mfma_f32_32x32x16_bf16 v[0:15], v[180:183], v[132:135], v[0:15]
    s_waitcnt lgkmcnt(6)
    s_barrier
    ds_read_b64_tr_b16 v[160:161], v206 offset:20480
    ds_read_b64_tr_b16 v[162:163], v206 offset:21760
    v_mfma_f32_32x32x16_bf16 v[16:31], v[184:187], v[132:135], v[16:31]
    s_waitcnt lgkmcnt(6)
    ds_read_b64_tr_b16 v[164:165], v206 offset:20544
    ds_read_b64_tr_b16 v[166:167], v206 offset:21824
    v_mfma_f32_32x32x16_bf16 v[32:47], v[188:191], v[132:135], v[32:47]
    s_waitcnt lgkmcnt(6)
    ds_read_b64_tr_b16 v[168:169], v206 offset:20608
    ds_read_b64_tr_b16 v[170:171], v206 offset:21888
    v_mfma_f32_32x32x16_bf16 v[48:63], v[192:195], v[132:135], v[48:63]
    s_waitcnt lgkmcnt(6)
    ds_read_b64_tr_b16 v[172:173], v206 offset:20672
    ds_read_b64_tr_b16 v[174:175], v206 offset:21952
    v_mfma_f32_32x32x16_bf16 v[64:79], v[196:199], v[132:135], v[64:79]
    s_waitcnt lgkmcnt(6) vmcnt(5)
    ds_read_b64_tr_b16 v[176:177], v206 offset:20736
    ds_read_b64_tr_b16 v[178:179], v206 offset:22016
    v_mfma_f32_32x32x16_bf16 v[0:15], v[160:163], v[136:139], v[0:15]
    s_waitcnt lgkmcnt(6)
    ds_read_b64_tr_b16 v[180:181], v206 offset:25600
    ds_read_b64_tr_b16 v[182:183], v206 offset:26880
    v_mfma_f32_32x32x16_bf16 v[16:31], v[164:167], v[136:139], v[16:31]
    s_waitcnt lgkmcnt(6)
    ds_read_b64_tr_b16 v[184:185], v206 offset:25664
    ds_read_b64_tr_b16 v[186:187], v206 offset:26944
    v_mfma_f32_32x32x16_bf16 v[32:47], v[168:171], v[136:139], v[32:47]
    s_waitcnt lgkmcnt(6)
    ds_read_b64_tr_b16 v[188:189], v206 offset:25728
    ds_read_b64_tr_b16 v[190:191], v206 offset:27008
    v_mfma_f32_32x32x16_bf16 v[48:63], v[172:175], v[136:139], v[48:63]
    s_waitcnt lgkmcnt(6)
    ds_read_b64_tr_b16 v[192:193], v206 offset:25792
    ds_read_b64_tr_b16 v[194:195], v206 offset:27072
    v_mfma_f32_32x32x16_bf16 v[64:79], v[176:179], v[136:139], v[64:79]
    s_waitcnt lgkmcnt(6) vmcnt(4)
    ds_read_b64_tr_b16 v[196:197], v206 offset:25856
    ds_read_b64_tr_b16 v[198:199], v206 offset:27136
    v_mfma_f32_32x32x16_bf16 v[0:15], v[180:183], v[140:143], v[0:15]
    s_waitcnt lgkmcnt(6)
    s_barrier
    ds_read_b64_tr_b16 v[160:161], v206 offset:40960
    ds_read_b64_tr_b16 v[162:163], v206 offset:42240
    v_mfma_f32_32x32x16_bf16 v[16:31], v[184:187], v[140:143], v[16:31]
    s_waitcnt lgkmcnt(6)
    ds_read_b64_tr_b16 v[164:165], v206 offset:41024
    ds_read_b64_tr_b16 v[166:167], v206 offset:42304
    v_mfma_f32_32x32x16_bf16 v[32:47], v[188:191], v[140:143], v[32:47]
    s_waitcnt lgkmcnt(6)
    ds_read_b64_tr_b16 v[168:169], v206 offset:41088
    ds_read_b64_tr_b16 v[170:171], v206 offset:42368
    v_mfma_f32_32x32x16_bf16 v[48:63], v[192:195], v[140:143], v[48:63]
    s_waitcnt lgkmcnt(6)
    ds_read_b64_tr_b16 v[172:173], v206 offset:41152
    ds_read_b64_tr_b16 v[174:175], v206 offset:42432
    v_mfma_f32_32x32x16_bf16 v[64:79], v[196:199], v[140:143], v[64:79]
    s_waitcnt lgkmcnt(6) vmcnt(3)
    ds_read_b64_tr_b16 v[176:177], v206 offset:41216
    ds_read_b64_tr_b16 v[178:179], v206 offset:42496
    v_mfma_f32_32x32x16_bf16 v[0:15], v[160:163], v[144:147], v[0:15]
    s_waitcnt lgkmcnt(6)
    ds_read_b64_tr_b16 v[180:181], v206 offset:46080
    ds_read_b64_tr_b16 v[182:183], v206 offset:47360
    v_mfma_f32_32x32x16_bf16 v[16:31], v[164:167], v[144:147], v[16:31]
    s_waitcnt lgkmcnt(6)
    ds_read_b64_tr_b16 v[184:185], v206 offset:46144
    ds_read_b64_tr_b16 v[186:187], v206 offset:47424
    v_mfma_f32_32x32x16_bf16 v[32:47], v[168:171], v[144:147], v[32:47]
    s_waitcnt lgkmcnt(6)
    ds_read_b64_tr_b16 v[188:189], v206 offset:46208
    ds_read_b64_tr_b16 v[190:191], v206 offset:47488
    v_mfma_f32_32x32x16_bf16 v[48:63], v[172:175], v[144:147], v[48:63]
    s_waitcnt lgkmcnt(6)
    ds_read_b64_tr_b16 v[192:193], v206 offset:46272
    ds_read_b64_tr_b16 v[194:195], v206 offset:47552
    v_mfma_f32_32x32x16_bf16 v[64:79], v[176:179], v[144:147], v[64:79]
    s_waitcnt lgkmcnt(6) vmcnt(2)
    ds_read_b64_tr_b16 v[196:197], v206 offset:46336
    ds_read_b64_tr_b16 v[198:199], v206 offset:47616
    v_mfma_f32_32x32x16_bf16 v[0:15], v[180:183], v[148:151], v[0:15]
    s_waitcnt lgkmcnt(6)
    s_barrier
    ds_read_b64_tr_b16 v[160:161], v207 offset:0
    ds_read_b64_tr_b16 v[162:163], v207 offset:1280
    v_mfma_f32_32x32x16_bf16 v[16:31], v[184:187], v[148:151], v[16:31]
    s_waitcnt lgkmcnt(6)
    ds_read_b64_tr_b16 v[164:165], v207 offset:64
    ds_read_b64_tr_b16 v[166:167], v207 offset:1344
    v_mfma_f32_32x32x16_bf16 v[32:47], v[188:191], v[148:151], v[32:47]
    s_waitcnt lgkmcnt(6)
    ds_read_b64_tr_b16 v[168:169], v207 offset:128
    ds_read_b64_tr_b16 v[170:171], v207 offset:1408
    v_mfma_f32_32x32x16_bf16 v[48:63], v[192:195], v[148:151], v[48:63]
    s_waitcnt lgkmcnt(6)
    ds_read_b64_tr_b16 v[172:173], v207 offset:192
    ds_read_b64_tr_b16 v[174:175], v207 offset:1472
    v_mfma_f32_32x32x16_bf16 v[64:79], v[196:199], v[148:151], v[64:79]
    s_waitcnt lgkmcnt(6) vmcnt(1)
    ds_read_b64_tr_b16 v[176:177], v207 offset:256
    ds_read_b64_tr_b16 v[178:179], v207 offset:1536
    v_mfma_f32_32x32x16_bf16 v[0:15], v[160:163], v[152:155], v[0:15]
    s_waitcnt lgkmcnt(6)
    ds_read_b64_tr_b16 v[180:181], v207 offset:5120
    ds_read_b64_tr_b16 v[182:183], v207 offset:6400
    v_mfma_f32_32x32x16_bf16 v[16:31], v[164:167], v[152:155], v[16:31]
    s_waitcnt lgkmcnt(6)
    ds_read_b64_tr_b16 v[184:185], v207 offset:5184
    ds_read_b64_tr_b16 v[186:187], v207 offset:6464
    v_mfma_f32_32x32x16_bf16 v[32:47], v[168:171], v[152:155], v[32:47]
    s_waitcnt lgkmcnt(6)
    ds_read_b64_tr_b16 v[188:189], v207 offset:5248
    ds_read_b64_tr_b16 v[190:191], v207 offset:6528
    v_mfma_f32_32x32x16_bf16 v[48:63], v[172:175], v[152:155], v[48:63]
    s_waitcnt lgkmcnt(6)
    ds_read_b64_tr_b16 v[192:193], v207 offset:5312
    ds_read_b64_tr_b16 v[194:195], v207 offset:6592
    v_mfma_f32_32x32x16_bf16 v[64:79], v[176:179], v[152:155], v[64:79]
    s_waitcnt lgkmcnt(6) vmcnt(0)
    ds_read_b64_tr_b16 v[196:197], v207 offset:5376
    ds_read_b64_tr_b16 v[198:199], v207 offset:6656
    v_mfma_f32_32x32x16_bf16 v[0:15], v[180:183], v[156:159], v[0:15]
    s_waitcnt lgkmcnt(6)
    v_mfma_f32_32x32x16_bf16 v[16:31], v[184:187], v[156:159], v[16:31]
    s_waitcnt lgkmcnt(4)
    v_mfma_f32_32x32x16_bf16 v[32:47], v[188:191], v[156:159], v[32:47]
    s_waitcnt lgkmcnt(2)
    v_mfma_f32_32x32x16_bf16 v[48:63], v[192:195], v[156:159], v[48:63]
    s_waitcnt lgkmcnt(0)
    v_mfma_f32_32x32x16_bf16 v[64:79], v[196:199], v[156:159], v[64:79]
    s_barrier
    s_cmp_eq_u32 s23, 0
    s_cbranch_scc0 P3_k1
    s_nop 7
    ds_write_b128 v219, v[40:43] offset:0
    ds_write_b128 v219, v[44:47] offset:1024
    ds_write_b128 v219, v[48:51] offset:2048
    ds_write_b128 v219, v[52:55] offset:3072
    ds_write_b128 v219, v[56:59] offset:4096
    ds_write_b128 v219, v[60:63] offset:5120
    ds_write_b128 v219, v[64:67] offset:6144
    ds_write_b128 v219, v[68:71] offset:7168
    ds_write_b128 v219, v[72:75] offset:8192
    ds_write_b128 v219, v[76:79] offset:9216
    s_waitcnt lgkmcnt(0)
    s_barrier
    ds_read_b128 v[80:83], v220 offset:0
    ds_read_b128 v[84:87], v220 offset:1024
    ds_read_b128 v[88:91], v220 offset:2048
    ds_read_b128 v[92:95], v220 offset:3072
    ds_read_b128 v[96:99], v220 offset:4096
    ds_read_b128 v[100:103], v220 offset:5120
    ds_read_b128 v[104:107], v220 offset:6144
    ds_read_b128 v[108:111], v220 offset:7168
    ds_read_b128 v[112:115], v220 offset:8192
    ds_read_b128 v[116:119], v220 offset:9216
    s_waitcnt lgkmcnt(9)
    v_pk_add_f32 v[80:81], v[80:81], v[0:1]
    v_pk_add_f32 v[82:83], v[82:83], v[2:3]
    v_cvt_pk_bf16_f32 v160, v80, v81
    v_cvt_pk_bf16_f32 v161, v82, v83
    s_waitcnt lgkmcnt(8)
    v_pk_add_f32 v[84:85], v[84:85], v[4:5]
    v_pk_add_f32 v[86:87], v[86:87], v[6:7]
    v_cvt_pk_bf16_f32 v162, v84, v85
    v_cvt_pk_bf16_f32 v163, v86, v87
    s_waitcnt lgkmcnt(7)
    v_pk_add_f32 v[88:89], v[88:89], v[8:9]
    v_pk_add_f32 v[90:91], v[90:91], v[10:11]
    v_cvt_pk_bf16_f32 v164, v88, v89
    v_cvt_pk_bf16_f32 v165, v90, v91
    s_waitcnt lgkmcnt(6)
    v_pk_add_f32 v[92:93], v[92:93], v[12:13]
    v_pk_add_f32 v[94:95], v[94:95], v[14:15]
    v_cvt_pk_bf16_f32 v166, v92, v93
    v_cvt_pk_bf16_f32 v167, v94, v95
    s_waitcnt lgkmcnt(5)
    v_pk_add_f32 v[96:97], v[96:97], v[16:17]
    v_pk_add_f32 v[98:99], v[98:99], v[18:19]
    v_cvt_pk_bf16_f32 v168, v96, v97
    v_cvt_pk_bf16_f32 v169, v98, v99
    s_waitcnt lgkmcnt(4)
    v_pk_add_f32 v[100:101], v[100:101], v[20:21]
    v_pk_add_f32 v[102:103], v[102:103], v[22:23]
    v_cvt_pk_bf16_f32 v170, v100, v101
    v_cvt_pk_bf16_f32 v171, v102, v103
    s_waitcnt lgkmcnt(3)
    v_pk_add_f32 v[104:105], v[104:105], v[24:25]
    v_pk_add_f32 v[106:107], v[106:107], v[26:27]
    v_cvt_pk_bf16_f32 v172, v104, v105
    v_cvt_pk_bf16_f32 v173, v106, v107
    s_waitcnt lgkmcnt(2)
    v_pk_add_f32 v[108:109], v[108:109], v[28:29]
    v_pk_add_f32 v[110:111], v[110:111], v[30:31]
    v_cvt_pk_bf16_f32 v174, v108, v109
    v_cvt_pk_bf16_f32 v175, v110, v111
    s_waitcnt lgkmcnt(1)
    v_pk_add_f32 v[112:113], v[112:113], v[32:33]
    v_pk_add_f32 v[114:115], v[114:115], v[34:35]
    v_cvt_pk_bf16_f32 v176, v112, v113
    v_cvt_pk_bf16_f32 v177, v114, v115
    s_waitcnt lgkmcnt(0)
    v_pk_add_f32 v[116:117], v[116:117], v[36:37]
    v_pk_add_f32 v[118:119], v[118:119], v[38:39]
    v_cvt_pk_bf16_f32 v178, v116, v117
    v_cvt_pk_bf16_f32 v179, v118, v119
    s_branch P3_fin
P3_k1:
    s_nop 7
    ds_write_b128 v219, v[0:3] offset:0
    ds_write_b128 v219, v[4:7] offset:1024
    ds_write_b128 v219, v[8:11] offset:2048
    ds_write_b128 v219, v[12:15] offset:3072
    ds_write_b128 v219, v[16:19] offset:4096
    ds_write_b128 v219, v[20:23] offset:5120
    ds_write_b128 v219, v[24:27] offset:6144
    ds_write_b128 v219, v[28:31] offset:7168
    ds_write_b128 v219, v[32:35] offset:8192
    ds_write_b128 v219, v[36:39] offset:9216
    s_waitcnt lgkmcnt(0)
    s_barrier
    ds_read_b128 v[80:83], v220 offset:0
    ds_read_b128 v[84:87], v220 offset:1024
    ds_read_b128 v[88:91], v220 offset:2048
    ds_read_b128 v[92:95], v220 offset:3072
    ds_read_b128 v[96:99], v220 offset:4096
    ds_read_b128 v[100:103], v220 offset:5120
    ds_read_b128 v[104:107], v220 offset:6144
    ds_read_b128 v[108:111], v220 offset:7168
    ds_read_b128 v[112:115], v220 offset:8192
    ds_read_b128 v[116:119], v220 offset:9216
    s_waitcnt lgkmcnt(9)
    v_pk_add_f32 v[80:81], v[80:81], v[40:41]
    v_pk_add_f32 v[82:83], v[82:83], v[42:43]
    v_cvt_pk_bf16_f32 v160, v80, v81
    v_cvt_pk_bf16_f32 v161, v82, v83
    s_waitcnt lgkmcnt(8)
    v_pk_add_f32 v[84:85], v[84:85], v[44:45]
    v_pk_add_f32 v[86:87], v[86:87], v[46:47]
    v_cvt_pk_bf16_f32 v162, v84, v85
    v_cvt_pk_bf16_f32 v163, v86, v87
    s_waitcnt lgkmcnt(7)
    v_pk_add_f32 v[88:89], v[88:89], v[48:49]
    v_pk_add_f32 v[90:91], v[90:91], v[50:51]
    v_cvt_pk_bf16_f32 v164, v88, v89
    v_cvt_pk_bf16_f32 v165, v90, v91
    s_waitcnt lgkmcnt(6)
    v_pk_add_f32 v[92:93], v[92:93], v[52:53]
    v_pk_add_f32 v[94:95], v[94:95], v[54:55]
    v_cvt_pk_bf16_f32 v166, v92, v93
    v_cvt_pk_bf16_f32 v167, v94, v95
    s_waitcnt lgkmcnt(5)
    v_pk_add_f32 v[96:97], v[96:97], v[56:57]
    v_pk_add_f32 v[98:99], v[98:99], v[58:59]
    v_cvt_pk_bf16_f32 v168, v96, v97
    v_cvt_pk_bf16_f32 v169, v98, v99
    s_waitcnt lgkmcnt(4)
    v_pk_add_f32 v[100:101], v[100:101], v[60:61]
    v_pk_add_f32 v[102:103], v[102:103], v[62:63]
    v_cvt_pk_bf16_f32 v170, v100, v101
    v_cvt_pk_bf16_f32 v171, v102, v103
    s_waitcnt lgkmcnt(3)
    v_pk_add_f32 v[104:105], v[104:105], v[64:65]
    v_pk_add_f32 v[106:107], v[106:107], v[66:67]
    v_cvt_pk_bf16_f32 v172, v104, v105
    v_cvt_pk_bf16_f32 v173, v106, v107
    s_waitcnt lgkmcnt(2)
    v_pk_add_f32 v[108:109], v[108:109], v[68:69]
    v_pk_add_f32 v[110:111], v[110:111], v[70:71]
    v_cvt_pk_bf16_f32 v174, v108, v109
    v_cvt_pk_bf16_f32 v175, v110, v111
    s_waitcnt lgkmcnt(1)
    v_pk_add_f32 v[112:113], v[112:113], v[72:73]
    v_pk_add_f32 v[114:115], v[114:115], v[74:75]
    v_cvt_pk_bf16_f32 v176, v112, v113
    v_cvt_pk_bf16_f32 v177, v114, v115
    s_waitcnt lgkmcnt(0)
    v_pk_add_f32 v[116:117], v[116:117], v[76:77]
    v_pk_add_f32 v[118:119], v[118:119], v[78:79]
    v_cvt_pk_bf16_f32 v178, v116, v117
    v_cvt_pk_bf16_f32 v179, v118, v119
P3_fin:
    ds_write_b64 v218, v[160:161] offset:0
    ds_write_b64 v218, v[162:163] offset:16
    ds_write_b64 v218, v[164:165] offset:32
    ds_write_b64 v218, v[166:167] offset:48
    ds_write_b64 v218, v[168:169] offset:64
    ds_write_b64 v218, v[170:171] offset:80
    ds_write_b64 v218, v[172:173] offset:96
    ds_write_b64 v218, v[174:175] offset:112
    ds_write_b64 v218, v[176:177] offset:128
    ds_write_b64 v218, v[178:179] offset:144
    s_waitcnt lgkmcnt(0)
    ds_read_b128 v[80:83], v213
    ds_read_b128 v[84:87], v214
    ds_read_b128 v[88:91], v215
    ds_read_b128 v[92:95], v216
    ds_read_b128 v[96:99], v217
    s_waitcnt lgkmcnt(4)
    global_store_dwordx4 v208, v[80:83], s[20:21] nt
    s_waitcnt lgkmcnt(3)
    global_store_dwordx4 v209, v[84:87], s[20:21] nt
    s_waitcnt lgkmcnt(2)
    global_store_dwordx4 v210, v[88:91], s[20:21] nt
    s_waitcnt lgkmcnt(1)
    global_store_dwordx4 v211, v[92:95], s[20:21] nt
    s_waitcnt lgkmcnt(0)
    global_store_dwordx4 v212, v[96:99], s[20:21] nt
    s_branch P3_end
P3_loader:
    s_waitcnt vmcnt(25)
    s_barrier
    s_waitcnt vmcnt(20)
    s_barrier
    s_waitcnt vmcnt(15)
    s_barrier
    s_add_u32 s27, s27, 1
    s_cmp_eq_u32 s27, 10
    s_cselect_b32 s27, 0, s27
    s_cselect_b32 s14, -368640, s28
    s_ashr_i32 s30, s14, 31
    s_add_u32 s16, s16, s14
    s_addc_u32 s17, s17, s30
    s_add_u32 m0, s25, 0
    s_nop 0
    global_load_lds_dwordx4 v208, s[16:17]
    s_add_u32 m0, s25, 1024
    s_nop 0
    global_load_lds_dwordx4 v209, s[16:17]
    s_add_u32 m0, s25, 2048
    s_nop 0
    global_load_lds_dwordx4 v210, s[16:17]
    s_add_u32 m0, s25, 3072
    s_nop 0
    global_load_lds_dwordx4 v211, s[16:17]
    s_add_u32 m0, s25, 4096
    s_nop 0
    global_load_lds_dwordx4 v212, s[16:17]
    s_waitcnt vmcnt(15)
    s_barrier
    s_add_u32 s27, s27, 1
    s_cmp_eq_u32 s27, 10
    s_cselect_b32 s27, 0, s27
    s_cselect_b32 s14, -368640, s28
    s_ashr_i32 s30, s14, 31
    s_add_u32 s16, s16, s14
    s_addc_u32 s17, s17, s30
    s_add_u32 m0, s25, 20480
    s_nop 0
    global_load_lds_dwordx4 v208, s[16:17]
    s_add_u32 m0, s25, 21504
    s_nop 0
    global_load_lds_dwordx4 v209, s[16:17]
    s_add_u32 m0, s25, 22528
    s_nop 0
    global_load_lds_dwordx4 v210, s[16:17]
    s_add_u32 m0, s25, 23552
    s_nop 0
    global_load_lds_dwordx4 v211, s[16:17]
    s_add_u32 m0, s25, 24576
    s_nop 0
    global_load_lds_dwordx4 v212, s[16:17]
    s_waitcnt vmcnt(15)
    s_barrier
    s_add_u32 s27, s27, 1
    s_cmp_eq_u32 s27, 10
    s_cselect_b32 s27, 0, s27
    s_cselect_b32 s14, -368640, s28
    s_ashr_i32 s30, s14, 31
    s_add_u32 s16, s16, s14
    s_addc_u32 s17, s17, s30
    s_add_u32 m0, s25, 40960
    s_nop 0
    global_load_lds_dwordx4 v208, s[16:17]
    s_add_u32 m0, s25, 41984
    s_nop 0
    global_load_lds_dwordx4 v209, s[16:17]
    s_add_u32 m0, s25, 43008
    s_nop 0
    global_load_lds_dwordx4 v210, s[16:17]
    s_add_u32 m0, s25, 44032
    s_nop 0
    global_load_lds_dwordx4 v211, s[16:17]
    s_add_u32 m0, s25, 45056
    s_nop 0
    global_load_lds_dwordx4 v212, s[16:17]
    s_waitcnt vmcnt(15)
    s_barrier
    s_add_u32 s27, s27, 1
    s_cmp_eq_u32 s27, 10
    s_cselect_b32 s27, 0, s27
    s_cselect_b32 s14, -368640, s28
    s_ashr_i32 s30, s14, 31
    s_add_u32 s16, s16, s14
    s_addc_u32 s17, s17, s30
    s_add_u32 m0, s25, 61440
    s_nop 0
    global_load_lds_dwordx4 v208, s[16:17]
    s_add_u32 m0, s25, 62464
    s_nop 0
    global_load_lds_dwordx4 v209, s[16:17]
    s_add_u32 m0, s25, 63488
    s_nop 0
    global_load_lds_dwordx4 v210, s[16:17]
    s_add_u32 m0, s25, 64512
    s_nop 0
    global_load_lds_dwordx4 v211, s[16:17]
    s_add_u32 m0, s25, 65536
    s_nop 0
    global_load_lds_dwordx4 v212, s[16:17]
    s_waitcnt vmcnt(15)
    s_barrier
    s_waitcnt vmcnt(10)
    s_barrier
    s_waitcnt vmcnt(5)
    s_barrier
    s_waitcnt vmcnt(0)
    s_barrier
    s_barrier
    s_barrier
P3_end:
fused_kernel_end:
    s_endpgm

.section .rodata,"a"
.p2align 6

.amdhsa_kernel fused_kernel
  .amdhsa_next_free_vgpr 240
  .amdhsa_next_free_sgpr 102
  .amdhsa_accum_offset 240
  .amdhsa_group_segment_fixed_size 0
  .amdhsa_kernarg_size 96
  .amdhsa_user_sgpr_count 2
  .amdhsa_user_sgpr_kernarg_segment_ptr 1
  .amdhsa_system_sgpr_workgroup_id_x 1
.end_amdhsa_kernel
```
